```python
import torch

def _softmax(x, axis=-1):
    return torch.softmax(x, dim=axis)
def _gelu(x):
    return torch.nn.functional.gelu(x, approximate="tanh")
def _silu(x):
    return torch.nn.functional.silu(x)
def _sigmoid(x):
    return torch.sigmoid(x)
def _layernorm(x, axis=-1, eps=1e-5):
    m = x.mean(dim=axis, keepdim=True)
    v = x.var(dim=axis, keepdim=True, unbiased=False)
    return (x - m) / torch.sqrt(v + eps)
def _scatter_add(tgt, idx, src, axis=0):
    return tgt.clone().index_add_(axis, idx, src)
def _segment_sum(src, seg, n):
    out = torch.zeros((n,) + src.shape[1:], dtype=src.dtype)
    return out.index_add_(0, seg, src)
def _pad(x, pw):
    flat = tuple(v for pair in reversed(pw) for v in pair)
    return torch.nn.functional.pad(x, flat)

kernel_name = 'recurrent_scan__sliding_block_cached__dense_activation_squared_relu__decode'

def setup_inputs():

    _w = (lambda a: (lambda t: t.to(torch.bfloat16) if t.is_floating_point() else t)(torch.as_tensor(a)))
    def _A_setup():
        B, Sq, D = 2, 1, 448
        Hq, Hkv, Sk, Dh = 16, 8, 8192, 256
        assert Hq % Hkv == 0, (Hq, Hkv)
        return {
            "x": _w((lambda *s: torch.randn(*s, dtype=torch.bfloat16) * 0.05)(B, Sq, D)),
            "k_cache": _w((lambda *s: torch.randn(*s, dtype=torch.bfloat16) * 0.8)(B, Hkv, Sk, Dh)),
            "v_cache": _w((lambda *s: torch.randn(*s, dtype=torch.bfloat16) * 0.2)(B, Hkv, Sk, Dh)),
            "wq": _w((lambda *s: torch.randn(*s, dtype=torch.bfloat16) * 0.8)(D, Hq * Dh) * (D ** -0.5)),
            "wo": _w((lambda *s: torch.randn(*s, dtype=torch.bfloat16) * 0.2)(Hq * Dh, D) * ((Hq * Dh) ** -0.5)),
        }
    _A_in = _A_setup()

    def _B_setup():
        B, S, D, F = 2, 1, 448, 1792
        return {
            "x": _w((lambda *s: torch.randn(*s, dtype=torch.bfloat16) * 0.05)(B, S, D)),
            "w1": _w((lambda *s: torch.randn(*s, dtype=torch.bfloat16) * 0.1)(D, F)),
            "b1": _w((lambda *s: torch.randn(*s, dtype=torch.bfloat16) * 0.4)(F)),
            "w2": _w((lambda *s: torch.randn(*s, dtype=torch.bfloat16) * 0.1)(F, D)),
            "b2": _w((lambda *s: torch.randn(*s, dtype=torch.bfloat16) * 6.4)(D)),
        }
    _B_in = _B_setup()

    return {
        "A_x": _A_in["x"],
        "A_k_cache": _A_in["k_cache"],
        "A_v_cache": _A_in["v_cache"],
        "A_wq": _A_in["wq"],
        "A_wo": _A_in["wo"],
        "B_x": _B_in["x"],
        "B_w1": _B_in["w1"],
        "B_b1": _B_in["b1"],
        "B_w2": _B_in["w2"],
        "B_b2": _B_in["b2"],
    }

def reference(A_x, A_k_cache, A_v_cache, A_wq, A_wo, B_x, B_w1, B_b1, B_w2, B_b2):
    def _A_ref(x, k_cache, v_cache, wq, wo):
        B, Sq, D = x.shape
        Hq, Dh = 16, 256
        Hkv, Sk = k_cache.shape[1], k_cache.shape[2]
        W = min(4096, max(256, Sk // 4))
        rep = Hq // Hkv
        q = (lambda x, *d: x.permute(*d))((x @ wq).reshape(B, Sq, Hq, Dh), 0, 2, 1, 3)
        k = (lambda x, n, axis: torch.repeat_interleave(x, n, dim=axis))(k_cache[:, :, Sk - W:, :], rep, axis=1)
        v = (lambda x, n, axis: torch.repeat_interleave(x, n, dim=axis))(v_cache[:, :, Sk - W:, :], rep, axis=1)
        scores = torch.einsum("bhqd,bhkd->bhqk", q, k) * (Dh ** -0.5)
        p = _softmax(scores, axis=-1)
        o = torch.einsum("bhqk,bhkd->bhqd", p, v)
        return (lambda x, *d: x.permute(*d))(o, 0, 2, 1, 3).reshape(B, Sq, Hq * Dh) @ wo

    def _B_ref(x, w1, b1, w2, b2):
        h = torch.einsum("bsd,df->bsf", x, w1) + b1
        zero = torch.zeros_like(h)
        r = torch.where(h > zero, h, zero)
        h = r * r
        out = torch.einsum("bsf,fd->bsd", h, w2) + b2
        return out

    x = A_x
    xn = _layernorm(x, axis=-1)
    s = _A_ref(xn, A_k_cache, A_v_cache, A_wq, A_wo)
    g = _silu(_B_ref(xn, B_w1, B_b1, B_w2, B_b2))
    return x + s * g
```

```asm
; @launch grid=(256,1,1) block=(960,1,1) lds=155392
.amdgcn_target "amdgcn-amd-amdhsa--gfx950"
.text
.globl recurrent_scan__sliding_block_cached__dense_activation_squared_relu__decode_kernel
.p2align 8
.type recurrent_scan__sliding_block_cached__dense_activation_squared_relu__decode_kernel,@function
recurrent_scan__sliding_block_cached__dense_activation_squared_relu__decode_kernel:
  s_cmp_ge_u32 s2, 256
  s_cbranch_scc1 L_exit
  s_load_dwordx8 s[8:15], s[0:1], 0
  s_load_dwordx2 s[16:17], s[0:1], 32
  s_load_dwordx8 s[20:27], s[0:1], 48
  s_load_dwordx2 s[28:29], s[0:1], 80
  s_load_dwordx2 s[30:31], s[0:1], 96
  v_lshrrev_b32 v4, 6, v0
  v_and_b32 v1, 63, v0
  v_mov_b32 v2, 155136
  v_readfirstlane_b32 s3, v4
  v_mov_b32 v3, 1
  s_and_b32 s4, s2, 7
  s_lshr_b32 s5, s2, 3
  s_xor_b32 s7, s5, 0
  s_and_b32 s6, s7, 1
  s_lshr_b32 s7, s7, 1
  s_cmp_lt_u32 s3, 4
  s_cbranch_scc1 L_loader
  s_cmp_ge_u32 s5, 4
  s_cbranch_scc1 L_nopf
  s_cmp_lg_u32 s3, 14
  s_cbranch_scc1 L_nopf
  s_getpc_b64 s[40:41]
L_pc:
  s_and_b32 s60, s5, 1
  s_mul_i32 s60, s60, 5632
  v_min_u32 v6, 43, v1
  v_lshl_add_u32 v6, v6, 7, s60
  s_add_u32 s40, s40, L_notloader-L_pc
  s_addc_u32 s41, s41, 0
  v_min_u32 v6, L_codeend-L_notloader, v6
  global_load_dword v124, v6, s[40:41]
L_nopf:
  s_cmp_lg_u32 s3, 4
  s_cbranch_scc1 L_nz
  v_mov_b32 v5, 0
  v_lshl_add_u32 v7, v1, 2, v2
  ds_write_b32 v7, v5
  s_waitcnt lgkmcnt(0)
L_nz:
  s_cmp_lg_u32 s3, 12
  s_cbranch_scc1 L_nox
  v_lshrrev_b32 v4, 5, v1
  v_and_b32 v5, 31, v1
  v_mul_u32_u24 v20, 896, v4
  v_lshl_add_u32 v20, v5, 5, v20
  s_mov_b32 exec_lo, 0x0fffffff
  s_mov_b32 exec_hi, 0x0fffffff
  s_waitcnt lgkmcnt(0)
  global_load_dwordx4 v[24:27], v20, s[8:9]
  global_load_dwordx4 v[28:31], v20, s[8:9] offset:16
  s_mov_b64 exec, -1
  s_barrier
  s_branch L_x0e
L_nox:
  s_branch L_notloader
L_pfbase:
L_loader:
  v_lshrrev_b32 v6, 3, v1
  v_bfe_u32 v7, v1, 1, 2
  v_bfe_u32 v8, v1, 4, 1
  s_and_b32 s59, s3, 1
  s_lshl_b32 s59, s59, 1
  v_or_b32 v8, s59, v8
  v_xor_b32 v7, v7, v8
  v_and_b32 v8, 1, v1
  v_lshl_or_b32 v7, v7, 1, v8
  v_lshlrev_b32 v5, 4, v7
  s_lshl_b32 s61, s3, 16
  v_lshl_add_u32 v12, v6, 13, v5
  v_add_u32 v12, s61, v12
  v_mov_b32 v13, v12
  v_mov_b32 v15, v12
  s_and_b32 s62, s5, 3
  s_mul_i32 s62, s62, 917504
  s_lshl_b32 s63, s4, 10
  s_add_u32 s62, s62, s63
  s_lshr_b32 s63, s5, 2
  s_lshl_b32 s63, s63, 7
  s_add_u32 s62, s62, s63
  s_lshl_b32 s19, s3, 10
  s_mov_b32 s39, 0x20000
  s_waitcnt lgkmcnt(0)
  s_add_u32 s36, s14, s62
  s_addc_u32 s37, s15, 0
  s_mov_b32 s38, 909440
  s_add_u32 m0, s19, 114688
  s_mov_b32 s18, 0
  s_mov_b32 s40, 262144
  s_mov_b32 s41, -1
  s_mov_b32 s42, 0
  v_mov_b32 v14, 155144
  s_setprio 3
L_grp:
  s_waitcnt vmcnt(5)
  buffer_load_dwordx4 v12, s[36:39], s18 offen nt lds
  s_addk_i32 m0, 4096
  s_add_u32 s18, s18, s40
  s_and_b32 s18, s18, s41
  s_waitcnt vmcnt(5)
  s_mov_b64 exec, 1
  ds_add_u32 v14, v3
  s_mov_b64 exec, -1
  v_add_u32 v14, 4, v14
  buffer_load_dwordx4 v13, s[36:39], s18 offen nt lds
  s_addk_i32 m0, 4096
  s_add_u32 s18, s18, s40
  s_and_b32 s18, s18, s41
  s_waitcnt vmcnt(5)
  buffer_load_dwordx4 v12, s[36:39], s18 offen nt lds
  s_addk_i32 m0, 4096
  s_add_u32 s18, s18, s40
  s_and_b32 s18, s18, s41
  s_waitcnt vmcnt(5)
  buffer_load_dwordx4 v13, s[36:39], s18 offen nt lds
  s_addk_i32 m0, 4096
  s_add_u32 s18, s18, s40
  s_and_b32 s18, s18, s41
  s_add_u32 s42, s42, 1
  s_cmp_eq_u32 s42, 1
  s_cbranch_scc1 L_g_t2
  s_cmp_eq_u32 s42, 2
  s_cbranch_scc1 L_g_k
  s_cmp_lg_u32 s42, s45
  s_cbranch_scc1 L_nobump
  v_add_u32 v14, 4, v14
L_nobump:
  s_cmp_eq_u32 s42, 6
  s_cbranch_scc1 L_g_v
  s_cmp_lt_u32 s42, 9
  s_cbranch_scc1 L_grp
  s_cmp_eq_u32 s42, 9
  s_cbranch_scc1 L_g_v3
  s_cmp_eq_u32 s42, 10
  s_cbranch_scc1 L_g_wo
L_drainW:
  s_waitcnt vmcnt(4)
  s_barrier
L_drainW2:
  s_waitcnt vmcnt(0)
  s_barrier
  s_branch L_ld_end
L_drain:
  s_waitcnt vmcnt(4)
  s_mov_b64 exec, 1
  ds_add_u32 v14, v3
  s_mov_b64 exec, -1
  v_add_u32 v14, 4, v14
L_drain2:
  s_waitcnt vmcnt(0)
  s_mov_b64 exec, 1
  ds_add_u32 v14, v3
L_ld_end:
  s_endpgm
L_g_t2:
  s_barrier
  s_sub_u32 s101, s4, 5
  s_and_b32 s101, s101, 7
  s_lshl_b32 s96, s101, 4
  s_add_u32 s96, s96, s5
  s_sub_u32 s99, 29, s5
  s_mul_i32 s99, s99, 7
  s_add_u32 s99, s99, s101
  s_min_u32 s99, s99, 98
  s_cmp_lt_u32 s5, 16
  s_cselect_b32 s96, s96, 112
  s_cmp_lt_u32 s101, 7
  s_cselect_b32 s99, s99, 98
  s_lshr_b32 s97, s96, 2
  s_and_b32 s98, s96, 3
  s_mul_i32 s100, s99, 9363
  s_lshr_b32 s100, s100, 16
  s_mul_i32 s101, s100, 7
  s_sub_u32 s101, s99, s101
  s_mul_i32 s60, s98, 401408
  s_lshl_b32 s61, s97, 7
  s_add_u32 s60, s60, s61
  s_mul_i32 s61, s100, 114688
  s_lshl_b32 s62, s101, 7
  s_add_u32 s61, s61, s62
  s_cmp_lt_u32 s99, 98
  s_cselect_b32 s38, 113920, 0
  s_movk_i32 s62, 896
  s_cmp_lt_u32 s96, 112
  s_cselect_b32 s36, s20, s24
  s_cselect_b32 s37, s21, s25
  s_cselect_b32 s60, s60, s61
  s_cselect_b32 s38, 397952, s38
  s_cselect_b32 s61, 3584, s62
  s_add_u32 s36, s36, s60
  s_addc_u32 s37, s37, 0
  s_lshl_b32 s62, s3, 3
  v_add_u32 v12, s62, v6
  v_mul_lo_u32 v12, v12, s61
  s_lshl_b32 s40, s61, 5
  s_mov_b32 s18, 0
  v_add_u32 v12, v12, v5
  v_mov_b32 v13, v12
  s_add_u32 m0, s19, 131072
  s_cmp_lg_u32 s38, 0
  s_cselect_b32 s45, 99, 4
  s_cbranch_scc1 L_grp
  s_mov_b32 s42, 2
L_g_k:
  v_lshrrev_b32 v7, 5, v1
  v_and_b32 v8, 31, v1
  s_lshl_b32 s61, s3, 1
  v_add_u32 v9, s61, v7
  v_xor_b32 v9, v9, v8
  v_lshlrev_b32 v9, 4, v9
  v_lshl_add_u32 v12, v7, 9, v9
  v_xor_b32 v13, 0x80, v12
  s_lshl_b32 s43, s6, 25
  s_lshl_b32 s62, s4, 22
  s_add_u32 s43, s43, s62
  s_lshl_b32 s62, s7, 16
  s_add_u32 s43, s43, s62
  s_add_u32 s43, s43, 0x300000
  s_add_u32 s36, s10, s43
  s_addc_u32 s37, s11, 0
  s_mov_b32 s38, 0x10000
  s_movk_i32 s40, 4096
  s_mov_b32 s41, 0xffff
  s_mul_i32 s18, s5, 20480
  s_add_u32 s18, s18, s19
  s_and_b32 s18, s18, s41
  s_add_u32 m0, s19, 0
  s_branch L_grp
L_g_v:
  v_add_u32 v9, s59, v7
  v_lshlrev_b32 v9, 1, v9
  v_xor_b32 v9, v9, v8
  v_lshlrev_b32 v9, 4, v9
  v_lshl_add_u32 v12, v7, 9, v9
  v_xor_b32 v13, 0x80, v12
  s_add_u32 s36, s12, s43
  s_addc_u32 s37, s13, 0
  s_branch L_grp
.fill (0x480-(.-recurrent_scan__sliding_block_cached__dense_activation_squared_relu__decode_kernel))/4, 4, 0xBF800000
L_notloader:
  s_branch L_nl2
L_g_v3:
  s_mov_b32 s63, 0
W_1:
  ds_read_b32 v4, v2 offset:68
  s_add_u32 s63, s63, 1
  s_waitcnt lgkmcnt(0)
  v_readfirstlane_b32 s60, v4
  s_cmp_ge_u32 s60, 4
  s_cbranch_scc1 D_2
  s_sleep 1
  s_cmp_lt_u32 s63, 131072
  s_cbranch_scc1 W_1
D_2:
  s_branch L_grp
L_g_wo:
  s_mov_b32 s44, s18
  v_mov_b32 v15, v12
  s_cmp_ge_u32 s5, 28
  s_cbranch_scc1 L_drain
  s_lshl_b32 s60, s4, 9
  s_and_b32 s62, s5, 3
  s_lshl_b32 s62, s62, 6
  s_add_u32 s60, s60, s62
  s_mul_i32 s60, s60, 896
  s_lshr_b32 s62, s5, 2
  s_lshl_b32 s62, s62, 7
  s_add_u32 s60, s60, s62
  s_add_u32 s36, s16, s60
  s_addc_u32 s37, s17, 0
  s_cmp_lt_u32 s5, 28
  s_cselect_b32 s38, 285952, 0
  v_bfe_u32 v7, v1, 3, 1
  v_lshrrev_b32 v8, 4, v1
  v_lshl_add_u32 v7, v7, 4, v8
  s_lshl_b32 s62, s3, 2
  v_add_u32 v7, s62, v7
  v_mul_u32_u24 v12, 896, v7
  v_add_u32 v12, v12, v5
  v_add_u32 v13, 215040, v12
  s_mov_b32 s18, 0
  s_movk_i32 s40, 14336
  s_mov_b32 s41, -1
  s_add_u32 m0, s19, 131072
  s_cmp_lg_u32 s45, 99
  s_cbranch_scc1 L_wo_go
  s_mov_b32 s63, 0
W_3:
  ds_read_b32 v4, v2 offset:92
  s_add_u32 s63, s63, 1
  s_waitcnt lgkmcnt(0)
  v_readfirstlane_b32 s60, v4
  s_cmp_ge_u32 s60, 4
  s_cbranch_scc1 D_4
  s_sleep 1
  s_cmp_lt_u32 s63, 131072
  s_cbranch_scc1 W_3
D_4:
L_wo_go:
  s_waitcnt vmcnt(4)
  s_mov_b64 exec, 1
  ds_add_u32 v14, v3
  s_mov_b64 exec, -1
  v_add_u32 v14, 4, v14
  s_waitcnt vmcnt(3)
  buffer_load_dwordx4 v12, s[36:39], s18 offen nt lds
  s_addk_i32 m0, 4096
  s_add_u32 s18, s18, s40
  buffer_load_dwordx4 v13, s[36:39], s18 offen nt lds
  s_addk_i32 m0, 4096
  s_add_u32 s18, s18, s40
  buffer_load_dwordx4 v12, s[36:39], s18 offen nt lds
  s_addk_i32 m0, 4096
  s_add_u32 s18, s18, s40
  buffer_load_dwordx4 v13, s[36:39], s18 offen nt lds
  s_addk_i32 m0, 4096
  s_add_u32 s18, s18, s40
  s_branch L_drainW
L_nl2:
  s_waitcnt lgkmcnt(0)
  s_load_dword s18, s[30:31], 0
  s_barrier
  s_mov_b32 s32, s30
  s_mov_b32 s33, s31
  s_mov_b32 s34, 4194304
  s_mov_b32 s35, 0x20000
  s_sub_u32 s101, s4, 5
  s_and_b32 s101, s101, 7
  s_lshl_b32 s96, s101, 4
  s_add_u32 s96, s96, s5
  s_sub_u32 s99, 29, s5
  s_mul_i32 s99, s99, 7
  s_add_u32 s99, s99, s101
  s_min_u32 s99, s99, 98
  s_cmp_lt_u32 s5, 16
  s_cselect_b32 s96, s96, 112
  s_cmp_lt_u32 s101, 7
  s_cselect_b32 s99, s99, 98
  s_lshr_b32 s97, s96, 2
  s_and_b32 s98, s96, 3
  s_mul_i32 s100, s99, 9363
  s_lshr_b32 s100, s100, 16
  s_mul_i32 s101, s100, 7
  s_sub_u32 s101, s99, s101
  s_cmp_ge_u32 s3, 12
  s_cbranch_scc1 L_x12
  s_sub_u32 s19, s3, 4
  s_and_b32 s40, s19, 3
  s_lshr_b32 s41, s19, 2
  s_mov_b32 s42, 131072
  s_and_b32 s43, s5, 3
  s_cmp_eq_u32 s41, 0
  s_cselect_b32 s42, 114688, s42
  s_cselect_b32 s43, s43, s98
  v_lshrrev_b32 v4, 4, v1
  v_bfe_u32 v5, v1, 2, 2
  v_lshl_add_u32 v6, v4, 3, v5
  v_lshlrev_b32 v20, 7, v6
  v_lshrrev_b32 v5, 1, v5
  v_and_b32 v4, 1, v4
  v_lshl_or_b32 v5, v4, 1, v5
  v_xor_b32 v5, s40, v5
  v_lshl_add_u32 v20, v5, 5, v20
  v_and_b32 v5, 3, v1
  v_lshl_add_u32 v20, v5, 3, v20
  v_add_u32 v20, s42, v20
  v_and_b32 v4, 1, v1
  v_mul_u32_u24 v21, 896, v4
  v_lshrrev_b32 v5, 4, v1
  v_lshl_add_u32 v21, v5, 4, v21
  s_mul_i32 s60, s43, 224
  s_add_u32 s60, s60, 151552
  v_add_u32 v21, s60, v21
  s_cmp_eq_u32 s41, 0
  s_cselect_b32 s60, 13, 6
  v_lshlrev_b32 v22, s60, v4
  v_bfe_u32 v5, v1, 1, 3
  v_lshl_add_u32 v22, v5, 3, v22
  v_mov_b32 v14, v22
  s_lshl_b32 s60, s4, 14
  s_lshl_b32 s61, s43, 11
  s_add_u32 s60, s60, s61
  s_lshr_b32 s61, s5, 2
  s_lshl_b32 s61, s61, 8
  s_add_u32 s60, s60, s61
  s_add_u32 s60, s60, 65536
  s_lshl_b32 s61, s96, 9
  s_add_u32 s61, s61, 196608
  s_cmp_eq_u32 s41, 0
  s_cselect_b32 s44, s60, s61
  s_add_u32 s61, s41, 6
  s_lshl_b32 s60, s40, s61
  s_add_u32 s44, s44, s60
  s_cmp_lg_u32 s41, 0
  s_cbranch_scc1 L_noclr
  v_bfe_u32 v4, v1, 4, 1
  v_lshlrev_b32 v5, 11, v4
  v_lshrrev_b32 v4, 5, v1
  v_lshl_add_u32 v5, v4, 10, v5
  v_bfe_u32 v4, v1, 2, 2
  v_lshl_add_u32 v5, v4, 8, v5
  v_and_b32 v4, 3, v1
  v_lshl_add_u32 v5, v4, 2, v5
  v_mov_b32 v6, -1
  s_lshl_b32 s60, s4, 2
  s_add_u32 s60, s60, s40
  s_lshl_b32 s60, s60, 1
  s_add_u32 s60, s60, s6
  s_lshl_b32 s60, s60, 8
  s_add_u32 s60, s60, s7
  s_lshl_b32 s60, s60, 4
  s_add_u32 s60, s60, 327680
  buffer_store_dword v6, v5, s[32:35], s60 offen
L_noclr:
  s_waitcnt lgkmcnt(0)
  s_mul_i32 s18, s18, 0x9E3779B1
  s_add_u32 s18, s18, 0x7F4A7C15
  s_getreg_b32 s58, hwreg(HW_REG_XCC_ID, 0, 4)
  s_add_u32 s58, s58, s18
  s_cmp_eq_u32 s41, 0
  s_cbranch_scc1 L_p0_go
  s_cmp_ge_u32 s96, 112
  s_cbranch_scc1 L_p0_done
L_p0_go:
  s_mov_b32 s63, 0
W_5:
  ds_read_b32 v4, v2 offset:64
  s_add_u32 s63, s63, 1
  s_waitcnt lgkmcnt(0)
  v_readfirstlane_b32 s60, v4
  s_cmp_ge_u32 s60, 1
  s_cbranch_scc1 D_6
  s_sleep 1
  s_cmp_lt_u32 s63, 131072
  s_cbranch_scc1 W_5
D_6:
  ds_read_b128 v[24:27], v21 offset:0
  ds_read_b128 v[28:31], v21 offset:64
  ds_read_b128 v[32:35], v21 offset:128
  ds_read_b128 v[36:39], v21 offset:192
  s_lshl_b32 s60, s41, 2
  s_add_u32 s60, s60, 155152
  v_mov_b32 v6, s60
  s_mov_b32 s63, 0
W_7:
  ds_read_b32 v4, v6
  s_add_u32 s63, s63, 1
  s_waitcnt lgkmcnt(0)
  v_readfirstlane_b32 s60, v4
  s_cmp_ge_u32 s60, 4
  s_cbranch_scc1 D_8
  s_sleep 1
  s_cmp_lt_u32 s63, 131072
  s_cbranch_scc1 W_7
D_8:
  ds_read_b64_tr_b16 v[40:41], v20 offset:0
  ds_read_b64_tr_b16 v[42:43], v20 offset:512
  ds_read_b64_tr_b16 v[44:45], v20 offset:4096
  ds_read_b64_tr_b16 v[46:47], v20 offset:4608
  ds_read_b64_tr_b16 v[48:49], v20 offset:8192
  ds_read_b64_tr_b16 v[50:51], v20 offset:8704
  ds_read_b64_tr_b16 v[52:53], v20 offset:12288
  ds_read_b64_tr_b16 v[54:55], v20 offset:12800
  s_waitcnt lgkmcnt(6)
  v_mfma_f32_16x16x32_bf16 v[56:59], v[24:27], v[40:43], 0
  s_waitcnt lgkmcnt(4)
  v_mfma_f32_16x16x32_bf16 v[56:59], v[28:31], v[44:47], v[56:59]
  s_waitcnt lgkmcnt(2)
  v_mfma_f32_16x16x32_bf16 v[56:59], v[32:35], v[48:51], v[56:59]
  s_waitcnt lgkmcnt(0)
  v_mfma_f32_16x16x32_bf16 v[56:59], v[36:39], v[52:55], v[56:59]
  v_and_b32 v4, 1, v1
  v_cmp_eq_u32 vcc, 0, v4
  s_mov_b64 exec, 1
  s_mul_i32 s60, s41, 24
  s_nop 0
  v_add_u32 v5, s60, v2
  ds_add_u32 v5, v3 offset:68
  s_mov_b64 exec, -1
  s_cmp_eq_u32 s41, 0
  s_cselect_b32 s60, s58, s18
  v_mov_b32 v13, s60
  s_nop 1
  v_mov_b32_dpp v6, v56 quad_perm:[1,0,3,2] row_mask:0xf bank_mask:0xf
  v_mov_b32_dpp v7, v57 quad_perm:[1,0,3,2] row_mask:0xf bank_mask:0xf
  v_cndmask_b32 v4, v7, v56, vcc
  v_cndmask_b32 v5, v57, v6, vcc
  v_cvt_pk_bf16_f32 v12, v4, v5
  s_add_u32 s59, s44, 2097152
  s_mov_b64 exec, 0xffff
  s_cmp_eq_u32 s41, 0
  s_cbranch_scc0 L_p0_h
  v_mov_b32 v8, v12
  v_mov_b32 v9, s58
  s_waitcnt vmcnt(0)
  buffer_store_dwordx2 v[8:9], v22, s[32:35], s44 offen
  s_branch L_p0_hd
L_p0_h:
  v_mov_b32 v8, v12
  v_mov_b32 v9, v13
  v_mov_b32 v11, v13
  v_mov_b32_dpp v10, v12 quad_perm:[2,3,2,3] row_mask:0xf bank_mask:0xf
  s_mov_b64 exec, 0x3333
  buffer_store_dwordx4 v[8:11], v22, s[32:35], s59 offen sc1
L_p0_hd:
  s_mov_b64 exec, -1
L_p0_done:
  v_lshlrev_b32 v20, 4, v1
  s_lshl_b32 s60, s4, 14
  s_lshl_b32 s61, s6, 13
  s_add_u32 s60, s60, s61
  s_lshl_b32 s61, s19, 10
  s_add_u32 s60, s60, s61
  s_add_u32 s44, s60, 65536
  v_lshrrev_b32 v4, 1, v1
  s_lshl_b32 s60, s19, 1
  v_xor_b32 v4, s60, v4
  v_lshlrev_b32 v21, 4, v4
  v_and_b32 v4, 1, v1
  v_lshl_add_u32 v21, v4, 3, v21
  s_lshl_b32 s60, s19, 9
  s_add_u32 s60, s60, 147456
  v_add_u32 v21, s60, v21
  s_mov_b32 s63, 0
W_9:
  ds_read_b32 v4, v2 offset:28
  s_add_u32 s63, s63, 1
  s_waitcnt lgkmcnt(0)
  v_readfirstlane_b32 s60, v4
  s_cmp_ge_u32 s60, 4
  s_cbranch_scc1 D_10
  s_sleep 2
  s_cmp_lt_u32 s63, 131072
  s_cbranch_scc1 W_9
D_10:
  s_mov_b32 s61, 0
  s_add_u32 s55, s44, 2097152
  s_mov_b32 s56, s58
  buffer_load_dwordx4 v[8:11], v20, s[32:35], s44 offen sc1
  s_branch L_qg_c
L_qg_l:
  s_add_u32 s61, s61, 1
  s_and_b32 s60, s61, 7
  s_cselect_b32 s54, s44, s55
  s_cselect_b32 s56, s58, s18
  s_cbranch_scc1 L_qg_n
  s_cmp_ge_u32 s61, 131072
  s_cbranch_scc1 L_qg_d
  s_mov_b64 s[52:53], exec
  s_mov_b64 exec, 1
  ds_write_b32 v2, v3 offset:88
  s_cmp_eq_u32 s41, 0
  s_cbranch_scc0 L_qg_h
  s_mov_b64 exec, 0xffff
  buffer_store_dwordx2 v[12:13], v14, s[32:35], s59 offen sc1
L_qg_h:
  s_mov_b64 exec, s[52:53]
  buffer_load_dwordx4 v[8:11], v20, s[32:35], s55 offen sc1
  s_waitcnt vmcnt(0)
  v_subrev_u32 v4, s18, v9
  v_subrev_u32 v5, s18, v11
  v_cmp_ne_u32 s[62:63], s58, v9
  v_or_b32 v4, v4, v5
  v_cmp_lt_u32 vcc, 15, v4
  s_andn2_b64 s[62:63], s[62:63], vcc
  s_cbranch_scc0 L_qg_e
  s_mov_b64 exec, 1
  ds_write_b32 v2, v3 offset:96
  s_branch L_qg_e
L_qg_n:
  buffer_load_dwordx4 v[8:11], v20, s[32:35], s54 offen sc1
L_qg_c:
  s_waitcnt vmcnt(0)
  v_xor_b32 v4, s56, v9
  v_xor_b32 v5, s56, v11
  v_or_b32 v4, v4, v5
  v_cmp_ne_u32 vcc, 0, v4
L_qg_e:
  s_cbranch_vccz L_qg_d
  s_mov_b64 exec, vcc
  s_sleep 8
  s_branch L_qg_l
L_qg_d:
  s_mov_b64 exec, -1
  ds_write2_b32 v21, v8, v10 offset0:0 offset1:1
  s_waitcnt lgkmcnt(0)
  s_mov_b64 exec, 1
  ds_add_u32 v2, v3 offset:72
  s_mov_b64 exec, -1
  s_cmp_ge_u32 s19, 4
  s_cbranch_scc1 L_qk_done
  v_and_b32 v5, 15, v1
  v_lshrrev_b32 v6, 4, v1
  v_xor_b32 v7, v5, v6
  s_lshl_b32 s60, s19, 14
  v_lshlrev_b32 v8, 9, v5
  v_add_u32 v8, s60, v8
  v_and_b32 v5, 7, v1
  v_lshlrev_b32 v9, 1, v5
  v_xor_b32 v9, v9, v6
  v_lshlrev_b32 v10, 9, v5
  v_add_u32 v10, 147456, v10
  v_xor_b32 v4, 0, v7
  v_lshl_add_u32 v120, v4, 4, v8
  v_xor_b32 v4, 0, v9
  v_lshl_add_u32 v124, v4, 4, v10
  v_xor_b32 v4, 4, v7
  v_lshl_add_u32 v121, v4, 4, v8
  v_xor_b32 v4, 4, v9
  v_lshl_add_u32 v125, v4, 4, v10
  v_xor_b32 v4, 8, v7
  v_lshl_add_u32 v122, v4, 4, v8
  v_xor_b32 v4, 8, v9
  v_lshl_add_u32 v126, v4, 4, v10
  v_xor_b32 v4, 12, v7
  v_lshl_add_u32 v123, v4, 4, v8
  v_xor_b32 v4, 12, v9
  v_lshl_add_u32 v127, v4, 4, v10
  s_lshl_b32 s60, s19, 2
  s_add_u32 s60, s60, 155160
  v_mov_b32 v6, s60
  s_mov_b32 s63, 0
W_11:
  ds_read_b32 v4, v6
  s_add_u32 s63, s63, 1
  s_waitcnt lgkmcnt(0)
  v_readfirstlane_b32 s60, v4
  s_cmp_ge_u32 s60, 4
  s_cbranch_scc1 D_12
  s_sleep 1
  s_cmp_lt_u32 s63, 131072
  s_cbranch_scc1 W_11
D_12:
  ds_read_b128 v[16:19], v120 offset:0
  ds_read_b128 v[20:23], v120 offset:8192
  ds_read_b128 v[24:27], v121 offset:0
  ds_read_b128 v[28:31], v121 offset:8192
  ds_read_b128 v[32:35], v122 offset:0
  ds_read_b128 v[36:39], v122 offset:8192
  ds_read_b128 v[40:43], v123 offset:0
  ds_read_b128 v[44:47], v123 offset:8192
  s_waitcnt lgkmcnt(0)
  ds_read_b128 v[48:51], v120 offset:256
  ds_read_b128 v[52:55], v120 offset:8448
  ds_read_b128 v[56:59], v121 offset:256
  ds_read_b128 v[60:63], v121 offset:8448
  ds_read_b128 v[64:67], v122 offset:256
  ds_read_b128 v[68:71], v122 offset:8448
  ds_read_b128 v[72:75], v123 offset:256
  ds_read_b128 v[76:79], v123 offset:8448
  s_mov_b32 s63, 0
L_fq_l:
  ds_read2_b32 v[4:5], v2 offset0:18 offset1:22
  s_add_u32 s63, s63, 1
  s_waitcnt lgkmcnt(0)
  v_readfirstlane_b32 s60, v4
  v_readfirstlane_b32 s61, v5
  s_cmp_ge_u32 s60, 8
  s_cbranch_scc1 L_fq_d
  s_cmp_eq_u32 s61, 0
  s_cbranch_scc1 L_fq_n
  s_mov_b64 exec, 0xffff
  buffer_store_dwordx2 v[12:13], v14, s[32:35], s59 offen sc1
  s_mov_b64 exec, -1
  s_sleep 32
L_fq_n:
  s_sleep 1
  s_cmp_lt_u32 s63, 131072
  s_cbranch_scc1 L_fq_l
L_fq_d:
  ds_read_b32 v15, v2 offset:88
  s_waitcnt lgkmcnt(0)
  ds_read_b128 v[80:83], v124 offset:0
  ds_read_b128 v[84:87], v125 offset:0
  ds_read_b128 v[88:91], v126 offset:0
  ds_read_b128 v[92:95], v127 offset:0
  ds_read_b128 v[96:99], v124 offset:256
  ds_read_b128 v[100:103], v125 offset:256
  ds_read_b128 v[104:107], v126 offset:256
  ds_read_b128 v[108:111], v127 offset:256
  s_waitcnt lgkmcnt(7)
  v_mfma_f32_16x16x32_bf16 v[112:115], v[16:19], v[80:83], 0
  v_mfma_f32_16x16x32_bf16 v[116:119], v[20:23], v[80:83], 0
  s_waitcnt lgkmcnt(6)
  v_mfma_f32_16x16x32_bf16 v[112:115], v[24:27], v[84:87], v[112:115]
  v_mfma_f32_16x16x32_bf16 v[116:119], v[28:31], v[84:87], v[116:119]
  s_waitcnt lgkmcnt(5)
  v_mfma_f32_16x16x32_bf16 v[112:115], v[32:35], v[88:91], v[112:115]
  v_mfma_f32_16x16x32_bf16 v[116:119], v[36:39], v[88:91], v[116:119]
  s_waitcnt lgkmcnt(4)
  v_mfma_f32_16x16x32_bf16 v[112:115], v[40:43], v[92:95], v[112:115]
  v_mfma_f32_16x16x32_bf16 v[116:119], v[44:47], v[92:95], v[116:119]
  s_waitcnt lgkmcnt(3)
  v_mfma_f32_16x16x32_bf16 v[112:115], v[48:51], v[96:99], v[112:115]
  v_mfma_f32_16x16x32_bf16 v[116:119], v[52:55], v[96:99], v[116:119]
  s_waitcnt lgkmcnt(2)
  v_mfma_f32_16x16x32_bf16 v[112:115], v[56:59], v[100:103], v[112:115]
  v_mfma_f32_16x16x32_bf16 v[116:119], v[60:63], v[100:103], v[116:119]
  s_waitcnt lgkmcnt(1)
  v_mfma_f32_16x16x32_bf16 v[112:115], v[64:67], v[104:107], v[112:115]
  v_mfma_f32_16x16x32_bf16 v[116:119], v[68:71], v[104:107], v[116:119]
  s_waitcnt lgkmcnt(0)
  v_mfma_f32_16x16x32_bf16 v[112:115], v[72:75], v[108:111], v[112:115]
  v_mfma_f32_16x16x32_bf16 v[116:119], v[76:79], v[108:111], v[116:119]
  v_and_b32 v4, 1, v1
  v_lshrrev_b32 v5, 4, v1
  v_lshlrev_b32 v44, 6, v4
  v_lshl_add_u32 v44, v5, 3, v44
  s_lshl_b32 s60, s19, 7
  s_add_u32 s60, s60, 153600
  v_add_u32 v44, s60, v44
  s_lshl_b32 s60, s19, 2
  s_add_u32 s60, s60, 154112
  v_lshlrev_b32 v45, 4, v4
  v_add_u32 v45, s60, v45
  s_mov_b32 s45, 1035512379
  v_add_f32_dpp v16, v112, v112 row_ror:4 row_mask:0xf bank_mask:0xf
  v_add_f32_dpp v17, v113, v113 row_ror:4 row_mask:0xf bank_mask:0xf
  v_add_f32_dpp v18, v114, v114 row_ror:4 row_mask:0xf bank_mask:0xf
  v_add_f32_dpp v19, v115, v115 row_ror:4 row_mask:0xf bank_mask:0xf
  v_add_f32_dpp v20, v116, v116 row_ror:4 row_mask:0xf bank_mask:0xf
  v_add_f32_dpp v21, v117, v117 row_ror:4 row_mask:0xf bank_mask:0xf
  v_add_f32_dpp v22, v118, v118 row_ror:4 row_mask:0xf bank_mask:0xf
  v_add_f32_dpp v23, v119, v119 row_ror:4 row_mask:0xf bank_mask:0xf
  v_add_f32_dpp v24, v16, v16 row_ror:2 row_mask:0xf bank_mask:0xf
  v_add_f32_dpp v25, v17, v17 row_ror:2 row_mask:0xf bank_mask:0xf
  v_add_f32_dpp v26, v18, v18 row_ror:2 row_mask:0xf bank_mask:0xf
  v_add_f32_dpp v27, v19, v19 row_ror:2 row_mask:0xf bank_mask:0xf
  v_add_f32_dpp v28, v20, v20 row_ror:2 row_mask:0xf bank_mask:0xf
  v_add_f32_dpp v29, v21, v21 row_ror:2 row_mask:0xf bank_mask:0xf
  v_add_f32_dpp v30, v22, v22 row_ror:2 row_mask:0xf bank_mask:0xf
  v_add_f32_dpp v31, v23, v23 row_ror:2 row_mask:0xf bank_mask:0xf
  v_max3_f32 v32, v24, v25, v26
  v_max3_f32 v33, v27, v28, v29
  v_max3_f32 v32, v32, v30, v31
  v_max_f32 v32, v32, v33
  v_mov_b32 v33, v32
  s_nop 1
  v_permlane16_swap_b32 v33, v32
  s_nop 0
  v_max_f32 v32, v32, v33
  v_mov_b32 v33, v32
  s_nop 1
  v_permlane32_swap_b32 v33, v32
  s_nop 0
  v_max_f32 v32, v32, v33
  v_mul_f32 v34, s45, v32
  v_fma_f32 v24, v24, s45, -v34
  v_fma_f32 v25, v25, s45, -v34
  v_fma_f32 v26, v26, s45, -v34
  v_fma_f32 v27, v27, s45, -v34
  v_fma_f32 v28, v28, s45, -v34
  v_fma_f32 v29, v29, s45, -v34
  v_fma_f32 v30, v30, s45, -v34
  v_fma_f32 v31, v31, s45, -v34
  v_exp_f32 v24, v24
  v_exp_f32 v25, v25
  v_exp_f32 v26, v26
  v_exp_f32 v27, v27
  v_exp_f32 v28, v28
  v_exp_f32 v29, v29
  v_exp_f32 v30, v30
  v_exp_f32 v31, v31
  s_nop 0
  v_cvt_pk_bf16_f32 v36, v24, v25
  v_cvt_pk_bf16_f32 v37, v26, v27
  v_cvt_pk_bf16_f32 v38, v28, v29
  v_cvt_pk_bf16_f32 v39, v30, v31
  v_add_f32 v24, v24, v25
  v_add_f32 v26, v26, v27
  v_add_f32 v28, v28, v29
  v_add_f32 v30, v30, v31
  v_add_f32 v24, v24, v26
  v_add_f32 v28, v28, v30
  v_add_f32 v35, v24, v28
  v_mov_b32 v33, v35
  s_nop 1
  v_permlane16_swap_b32 v33, v35
  s_nop 0
  v_add_f32 v35, v35, v33
  v_mov_b32 v33, v35
  s_nop 1
  v_permlane32_swap_b32 v33, v35
  s_nop 0
  v_add_f32 v35, v35, v33
  s_mov_b32 s60, 0x00030003
  s_mov_b32 s61, 0x00030003
  s_mov_b64 exec, s[60:61]
  ds_write_b64 v44, v[36:37]
  ds_write_b64 v44, v[38:39] offset:32
  s_mov_b64 exec, 3
  ds_write2_b32 v45, v32, v35 offset0:0 offset1:8
  s_mov_b64 exec, -1
  s_waitcnt lgkmcnt(0)
  s_mov_b64 exec, 1
  ds_add_u32 v2, v3 offset:76
  s_mov_b64 exec, -1
  v_readfirstlane_b32 s60, v15
  s_cmp_eq_u32 s60, 0
  s_cbranch_scc1 L_qk_done
  s_mov_b64 exec, 0xffff
  buffer_store_dwordx2 v[12:13], v14, s[32:35], s59 offen sc1
  s_mov_b64 exec, -1
L_qk_done:
  v_lshrrev_b32 v4, 4, v1
  v_bfe_u32 v5, v1, 2, 2
  v_lshl_add_u32 v6, v4, 3, v5
  v_lshlrev_b32 v20, 9, v6
  v_and_b32 v6, 1, v4
  v_lshl_or_b32 v5, v6, 2, v5
  s_lshl_b32 s60, s19, 1
  v_xor_b32 v5, s60, v5
  v_lshl_add_u32 v20, v5, 5, v20
  v_and_b32 v5, 3, v1
  v_lshl_add_u32 v20, v5, 3, v20
  v_add_u32 v20, 65536, v20
  v_xor_b32 v21, 32, v20
  v_bfe_u32 v5, v1, 2, 1
  v_lshlrev_b32 v22, 6, v5
  v_lshl_add_u32 v22, v4, 4, v22
  v_add_u32 v22, 153600, v22
  v_lshlrev_b32 v23, 4, v6
  v_add_u32 v23, 154112, v23
  s_mov_b32 s45, 1035512379
  s_lshl_b32 s60, s4, 2
  s_lshr_b32 s61, s19, 1
  s_add_u32 s60, s60, s61
  s_lshl_b32 s60, s60, 5
  s_lshl_b32 s61, s6, 4
  s_add_u32 s60, s60, s61
  s_add_u32 s60, s60, s7
  s_lshl_b32 s60, s60, 9
  s_and_b32 s50, s19, 1
  s_lshl_b32 s61, s50, 7
  s_add_u32 s60, s60, s61
  s_add_u32 s44, s60, 327680
  s_add_u32 s49, s44, 2097152
  v_and_b32 v7, 15, v1
  v_lshlrev_b32 v12, 8, v6
  v_lshl_add_u32 v12, v7, 3, v12
  s_lshl_b32 s60, s4, 2
  s_and_b32 s62, s5, 3
  s_add_u32 s47, s60, s62
  s_lshl_b32 s60, s47, 14
  s_add_u32 s60, s60, s61
  s_lshl_b32 s61, s41, 13
  s_add_u32 s60, s60, s61
  s_bfe_u32 s51, s19, 0x10001
  s_lshl_b32 s61, s51, 8
  s_add_u32 s60, s60, s61
  s_add_u32 s46, s60, 327680
  v_lshlrev_b32 v13, 9, v7
  v_lshl_add_u32 v13, v4, 5, v13
  s_lshl_b32 s60, s19, 8
  s_add_u32 s60, s60, 16384
  v_lshlrev_b32 v14, 2, v1
  v_add_u32 v14, s60, v14
  s_lshr_b32 s60, s19, 1
  s_lshl_b32 s60, s60, 6
  s_add_u32 s60, s60, 154368
  v_lshlrev_b32 v19, 4, v4
  v_add_u32 v19, s60, v19
  v_lshlrev_b32 v11, 3, v1
  v_and_b32 v98, 0x1f0, v11
  v_lshrrev_b32 v98, 1, v98
  v_and_b32 v5, 1, v1
  v_lshlrev_b32 v5, 4, v5
  v_sub_u32 v102, 16, v5
  s_lshr_b32 s62, s5, 2
  s_lshl_b32 s60, s4, 3
  s_add_u32 s60, s60, s62
  s_lshl_b32 s60, s60, 1
  s_add_u32 s60, s60, s41
  s_lshl_b32 s60, s60, 8
  s_add_u32 s39, s60, 1179648
  s_lshl_b32 s60, s62, 7
  s_mul_i32 s61, s41, 896
  s_add_u32 s60, s60, s61
  v_lshlrev_b32 v99, 1, v1
  v_add_u32 v99, s60, v99
  s_lshl_b32 s62, s62, 1
  s_add_u32 s36, s62, s41
  s_mul_i32 s60, s36, 512
  s_add_u32 s48, s60, 1097728
  v_lshrrev_b32 v4, 3, v1
  v_mul_u32_u24 v105, 64, v4
  v_and_b32 v4, 7, v1
  v_lshl_add_u32 v105, v4, 3, v105
  s_lshl_b32 s60, s41, 2
  s_add_u32 s60, s60, 155240
  v_mov_b32 v106, s60
  s_lshl_b32 s60, s36, 14
  s_add_u32 s37, s60, 851968
  s_lshl_b32 s60, s47, 9
  s_add_u32 s38, s37, s60
  s_lshl_b32 s50, s50, 13
  s_lshl_b32 s51, s51, 12
  s_add_u32 s50, s50, s51
  s_add_u32 s50, s50, 131072
  v_lshrrev_b32 v4, 4, v1
  v_bfe_u32 v5, v1, 2, 2
  v_lshl_add_u32 v6, v4, 3, v5
  v_lshlrev_b32 v15, 7, v6
  v_lshrrev_b32 v5, 1, v5
  v_and_b32 v4, 1, v4
  v_lshl_or_b32 v5, v4, 1, v5
  v_xor_b32 v5, 0, v5
  v_lshl_add_u32 v15, v5, 5, v15
  v_and_b32 v5, 3, v1
  v_lshl_add_u32 v15, v5, 3, v15
  v_add_u32 v15, s50, v15
  v_xor_b32 v16, 32, v15
  v_xor_b32 v17, 64, v15
  v_xor_b32 v18, 0x60, v15
  v_lshlrev_b32 v96, 4, v1
  v_bfe_u32 v4, v1, 4, 1
  v_lshlrev_b32 v97, 11, v4
  v_bfe_u32 v4, v1, 2, 2
  v_lshl_add_u32 v97, v4, 8, v97
  v_and_b32 v4, 3, v1
  v_lshl_add_u32 v97, v4, 2, v97
  s_lshl_b32 s60, s4, 2
  s_lshr_b32 s61, s19, 1
  s_add_u32 s60, s60, s61
  s_lshl_b32 s60, s60, 13
  s_lshl_b32 s61, s6, 12
  s_add_u32 s60, s60, s61
  s_and_b32 s62, s19, 1
  s_lshl_b32 s62, s62, 10
  s_add_u32 s60, s60, s62
  s_lshl_b32 s61, s7, 4
  s_add_u32 s60, s60, s61
  s_add_u32 s56, s60, 327680
  s_lshl_b32 s60, s47, 13
  s_lshl_b32 s61, s19, 10
  s_add_u32 s60, s60, s61
  s_add_u32 s57, s60, 327680
  s_and_b32 s60, s19, 3
  s_cbranch_scc1 L_c_nox
  s_cmp_ge_u32 s5, 28
  s_cbranch_scc1 L_c_nox
  global_load_ushort v103, v99, s[8:9]
L_c_nox:
  s_mov_b32 s63, 0
W_13:
  ds_read_b32 v4, v2 offset:76
  s_add_u32 s63, s63, 1
  s_waitcnt lgkmcnt(0)
  v_readfirstlane_b32 s60, v4
  s_cmp_ge_u32 s60, 4
  s_cbranch_scc1 D_14
  s_sleep 1
  s_cmp_lt_u32 s63, 131072
  s_cbranch_scc1 W_13
D_14:
  ds_read_b32 v5, v2 offset:96
  ds_read_b128 v[56:59], v23
  ds_read_b128 v[24:27], v22 offset:0
  ds_read_b128 v[28:31], v22 offset:128
  ds_read_b128 v[32:35], v22 offset:256
  ds_read_b128 v[36:39], v22 offset:384
  s_waitcnt lgkmcnt(4)
  v_readfirstlane_b32 s59, v5
  s_add_u32 s55, s46, 2097152
  s_cmp_eq_u32 s59, 0
  s_cselect_b32 s58, -1, 0
  v_max3_f32 v4, v56, v57, v58
  v_max_f32 v4, v4, v59
  v_mul_f32 v4, s45, v4
  v_fma_f32 v56, v56, s45, -v4
  v_fma_f32 v57, v57, s45, -v4
  v_fma_f32 v58, v58, s45, -v4
  v_fma_f32 v59, v59, s45, -v4
  v_exp_f32 v56, v56
  v_exp_f32 v57, v57
  v_exp_f32 v58, v58
  v_exp_f32 v59, v59
  v_mov_b32 v69, s18
  s_mov_b32 s63, 0
W_15:
  ds_read_b32 v4, v2 offset:40
  s_add_u32 s63, s63, 1
  s_waitcnt lgkmcnt(0)
  v_readfirstlane_b32 s60, v4
  s_cmp_ge_u32 s60, 4
  s_cbranch_scc1 D_16
  s_sleep 1
  s_cmp_lt_u32 s63, 131072
  s_cbranch_scc1 W_15
D_16:
  ds_read_b64_tr_b16 v[40:41], v20 offset:0
  ds_read_b64_tr_b16 v[42:43], v20 offset:2048
  ds_read_b64_tr_b16 v[44:45], v21 offset:0
  ds_read_b64_tr_b16 v[46:47], v21 offset:2048
  s_waitcnt lgkmcnt(2)
  v_mfma_f32_16x16x32_bf16 v[48:51], v[24:27], v[40:43], 0
  s_waitcnt lgkmcnt(0)
  v_mfma_f32_16x16x32_bf16 v[52:55], v[24:27], v[44:47], 0
  s_nop 5
  v_mul_f32 v64, v56, v48
  s_nop 0
  v_mul_f32 v66, v56, v52
  s_mov_b32 s63, 0
W_17:
  ds_read_b32 v4, v2 offset:44
  s_add_u32 s63, s63, 1
  s_waitcnt lgkmcnt(0)
  v_readfirstlane_b32 s60, v4
  s_cmp_ge_u32 s60, 4
  s_cbranch_scc1 D_18
  s_sleep 1
  s_cmp_lt_u32 s63, 131072
  s_cbranch_scc1 W_17
D_18:
  ds_read_b64_tr_b16 v[40:41], v20 offset:16384
  ds_read_b64_tr_b16 v[42:43], v20 offset:18432
  ds_read_b64_tr_b16 v[44:45], v21 offset:16384
  ds_read_b64_tr_b16 v[46:47], v21 offset:18432
  s_waitcnt lgkmcnt(2)
  v_mfma_f32_16x16x32_bf16 v[48:51], v[28:31], v[40:43], 0
  s_waitcnt lgkmcnt(0)
  v_mfma_f32_16x16x32_bf16 v[52:55], v[28:31], v[44:47], 0
  s_nop 5
  v_fmac_f32 v64, v57, v48
  s_nop 0
  v_fmac_f32 v66, v57, v52
  s_mov_b32 s63, 0
W_19:
  ds_read_b32 v4, v2 offset:48
  s_add_u32 s63, s63, 1
  s_waitcnt lgkmcnt(0)
  v_readfirstlane_b32 s60, v4
  s_cmp_ge_u32 s60, 4
  s_cbranch_scc1 D_20
  s_sleep 1
  s_cmp_lt_u32 s63, 131072
  s_cbranch_scc1 W_19
D_20:
  ds_read_b64_tr_b16 v[40:41], v20 offset:32768
  ds_read_b64_tr_b16 v[42:43], v20 offset:34816
  ds_read_b64_tr_b16 v[44:45], v21 offset:32768
  ds_read_b64_tr_b16 v[46:47], v21 offset:34816
  s_waitcnt lgkmcnt(2)
  v_mfma_f32_16x16x32_bf16 v[48:51], v[32:35], v[40:43], 0
  s_waitcnt lgkmcnt(0)
  v_mfma_f32_16x16x32_bf16 v[52:55], v[32:35], v[44:47], 0
  s_nop 5
  v_fmac_f32 v64, v58, v48
  s_nop 0
  v_fmac_f32 v66, v58, v52
  s_cmp_lt_u32 s5, 28
  s_cbranch_scc1 L_c_ba
  s_mov_b32 s63, 0
W_21:
  ds_read_b32 v4, v2 offset:52
  s_add_u32 s63, s63, 1
  s_waitcnt lgkmcnt(0)
  v_readfirstlane_b32 s60, v4
  s_cmp_ge_u32 s60, 4
  s_cbranch_scc1 D_22
  s_nop 0
  s_cmp_lt_u32 s63, 131072
  s_cbranch_scc1 W_21
D_22:
  s_branch L_c_v3
L_tt1:
  s_branch L_tt_r
L_c_ba:
  s_barrier
L_c_v3:
  ds_read_b64_tr_b16 v[40:41], v20 offset:49152
  ds_read_b64_tr_b16 v[42:43], v20 offset:51200
  ds_read_b64_tr_b16 v[44:45], v21 offset:49152
  ds_read_b64_tr_b16 v[46:47], v21 offset:51200
  s_waitcnt lgkmcnt(2)
  v_mfma_f32_16x16x32_bf16 v[48:51], v[36:39], v[40:43], 0
  s_waitcnt lgkmcnt(0)
  v_mfma_f32_16x16x32_bf16 v[52:55], v[36:39], v[44:47], 0
  s_nop 5
  v_fmac_f32 v64, v59, v48
  s_nop 0
  v_fmac_f32 v66, v59, v52
  v_cvt_pk_bf16_f32 v68, v64, v66
  s_mov_b32 exec_hi, 0
  v_min_u32 v68, -2, v68
  buffer_store_dword v68, v97, s[32:35], s56 offen
  s_cmp_lg_u32 s59, 0
  s_cbranch_scc1 L_c_glob
  s_mov_b64 exec, -1
  s_cmp_ge_u32 s5, 28
  s_cbranch_scc1 L_c_fin
  s_mov_b32 s61, 0
  buffer_load_dwordx4 v[88:91], v96, s[32:35], s57 offen sc1
  s_barrier
  ds_read_b64_tr_b16 v[72:73], v15
  ds_read_b64_tr_b16 v[74:75], v15 offset:512
  ds_read_b64_tr_b16 v[76:77], v16
  ds_read_b64_tr_b16 v[78:79], v16 offset:512
  ds_read_b64_tr_b16 v[80:81], v17
  ds_read_b64_tr_b16 v[82:83], v17 offset:512
  ds_read_b64_tr_b16 v[84:85], v18
  ds_read_b64_tr_b16 v[86:87], v18 offset:512
  s_mov_b64 vcc, -1
L_pp:
  ds_read_b32 v10, v2 offset:84
  ds_read_b128 v[64:67], v19
  s_mov_b64 exec, vcc
  s_waitcnt vmcnt(0)
  v_max3_u32 v4, v88, v89, v90
  v_max_u32 v4, v4, v91
  v_cmp_eq_u32 vcc, -1, v4
  s_cbranch_vccnz L_pp_r
L_pp_d:
  s_mov_b64 exec, -1
  s_nop 1
  s_waitcnt lgkmcnt(2)
  v_mfma_f32_16x16x32_bf16 v[40:43], v[88:91], v[72:75], 0
  v_mfma_f32_16x16x32_bf16 v[44:47], v[88:91], v[76:79], 0
  v_mfma_f32_16x16x32_bf16 v[48:51], v[88:91], v[80:83], 0
  v_mfma_f32_16x16x32_bf16 v[52:55], v[88:91], v[84:87], 0
  s_waitcnt lgkmcnt(0)
  v_readfirstlane_b32 s60, v10
  s_cmp_ge_u32 s60, 1
  s_cbranch_scc0 L_wslow
WW_27:
  s_nop 1
  v_mul_f32 v56, v64, v40
  v_mul_f32 v57, v64, v44
  v_mul_f32 v58, v64, v48
  v_mul_f32 v59, v64, v52
  v_fmac_f32 v56, v65, v41
  v_fmac_f32 v57, v65, v45
  v_fmac_f32 v58, v65, v49
  v_fmac_f32 v59, v65, v53
  v_fmac_f32 v56, v66, v42
  v_fmac_f32 v57, v66, v46
  v_fmac_f32 v58, v66, v50
  v_fmac_f32 v59, v66, v54
  v_fmac_f32 v56, v67, v43
  v_fmac_f32 v57, v67, v47
  v_fmac_f32 v58, v67, v51
  v_fmac_f32 v59, v67, v55
  v_mov_b32 v9, s18
  v_permlane32_swap_b32 v56, v58
  s_nop 0
  v_permlane32_swap_b32 v57, v59
  v_add_f32 v56, v56, v58
  v_add_f32 v57, v57, v59
  s_nop 1
  v_permlane16_swap_b32 v56, v57
  s_nop 0
  s_and_b32 s60, s19, 3
  v_add_f32 v56, v56, v57
  ds_write_b32 v14, v56
  s_waitcnt lgkmcnt(0)
  s_barrier
  s_cbranch_scc1 L_c_fin
  ds_read2st64_b32 v[56:57], v14 offset0:0 offset1:1
  ds_read2st64_b32 v[58:59], v14 offset0:2 offset1:3
  v_mov_b32 v5, 0x1001
  s_mov_b32 s60, 0x42800000
  s_mov_b32 s61, 0x35800000
  s_waitcnt lgkmcnt(0)
  v_add_f32 v56, v56, v57
  v_add_f32 v58, v58, v59
  v_add_f32 v8, v56, v58
  v_cmp_gt_f32 vcc, s60, |v8|
  v_cmp_le_f32 s[52:53], s61, |v8|
  v_mul_f32 v4, 0x49800000, v8
  v_cndmask_b32 v4, 0, v4, vcc
  v_cndmask_b32 v5, 1, v5, s[52:53]
  v_fract_f32 v6, v4
  v_cndmask_b32 v7, 64, 0, vcc
  v_mul_f32 v6, 0x46800000, v6
  v_cvt_flr_i32_f32 v61, v4
  v_cvt_u32_f32 v6, v6
  v_or_b32 v5, v5, v7
  s_nand_b64 exec, vcc, s[52:53]
  s_cbranch_scc1 L_c_sp
L_c_spd:
  s_mov_b64 exec, -1
  v_mov_b32 v63, v61
  v_lshl_or_b32 v62, v6, 18, v5
  v_lshl_or_b32 v60, v6, 18, v5
  buffer_atomic_add_x2 v[62:63], v105, s[32:35], s48 offen sc0 sc1
  buffer_load_dwordx2 v[100:101], v98, s[32:35], s39 offen sc1
  s_mov_b32 s60, 0x35800000
  v_lshlrev_b32 v65, 16, v103
  s_waitcnt vmcnt(1)
  v_add_co_u32 v62, vcc, v62, v60
  v_and_b32 v4, 63, v62
  v_lshrrev_b32 v6, 18, v62
  v_addc_co_u32 v63, vcc, v63, v61, vcc
  v_cmp_eq_u32 vcc, 32, v4
  v_cvt_f32_u32 v6, v6
  v_cvt_f32_i32 v7, v63
  s_and_b64 exec, exec, vcc
  s_cbranch_execz L_c_fin
  v_bfe_u32 v4, v62, 6, 6
  v_bfe_u32 v5, v62, 12, 6
  v_mul_f32 v6, 0x2E800000, v6
  v_cmp_ne_u32 vcc, 0, v4
  v_cmp_eq_u32 s[52:53], 0, v5
  v_fma_f32 v6, v7, s60, v6
  s_or_b64 vcc, vcc, s[52:53]
  s_cbranch_scc1 L_c_slow
L_c_out:
  s_waitcnt vmcnt(0)
  v_cmp_ne_u32 vcc, s18, v101
  s_cbranch_vccnz L_c_gw
L_c_gok:
  v_lshlrev_b32 v64, v102, v100
  v_and_b32 v64, 0xffff0000, v64
  v_cvt_pk_bf16_f32 v6, v6, v6
  v_lshlrev_b32 v6, 16, v6
  v_mul_f32 v6, v6, v64
  v_cvt_pk_bf16_f32 v6, v6, v6
  v_lshlrev_b32 v6, 16, v6
  v_add_f32 v6, v6, v65
  v_cvt_pk_bf16_f32 v6, v6, v6
  global_store_short v99, v6, s[28:29]
  s_cmp_lg_u32 s36, 0
  s_cbranch_scc1 L_c_fin
  s_and_b64 exec, exec, 1
  s_cbranch_execz L_c_fin
  global_store_dword v11, v9, s[30:31]
L_c_fin:
  s_endpgm
L_pp_r:
  s_mov_b64 exec, vcc
  buffer_load_dwordx4 v[88:91], v96, s[32:35], s57 offen sc1
  s_mov_b64 exec, -1
  s_bcnt1_i32_b64 s60, vcc
  s_cmp_le_u32 s60, 32
  s_cbranch_scc1 PQ_26
  s_sleep 3
PQ_26:
  s_add_u32 s61, s61, 1
  s_cmp_lt_u32 s61, 131072
  s_cbranch_scc1 L_pp
  s_branch L_pp_d
L_wslow:
  s_mov_b32 s63, 0
W_29:
  ds_read_b32 v4, v2 offset:84
  s_add_u32 s63, s63, 1
  s_waitcnt lgkmcnt(0)
  v_readfirstlane_b32 s60, v4
  s_cmp_ge_u32 s60, 1
  s_cbranch_scc1 D_30
  s_sleep 1
  s_cmp_lt_u32 s63, 131072
  s_cbranch_scc1 W_29
D_30:
  ds_read_b128 v[64:67], v19
  s_waitcnt lgkmcnt(0)
  s_branch WW_27
L_c_gw:
  s_mov_b64 s[50:51], exec
  s_mov_b32 s61, 0
  s_add_u32 s55, s39, 2097152
L_c_gl:
  s_add_u32 s61, s61, 1
  s_and_b32 s60, s61, s58
  s_cselect_b32 s54, s39, s55
  s_mov_b64 exec, vcc
  buffer_load_dwordx2 v[100:101], v98, s[32:35], s54 offen sc1
  s_cmp_ge_u32 s61, 131072
  s_waitcnt vmcnt(0)
  v_cmp_ne_u32 vcc, s18, v101
  s_mov_b64 exec, s[50:51]
  s_cbranch_scc1 L_c_gok
  s_cbranch_vccz L_c_gok
  s_sleep 2
  s_branch L_c_gl
L_c_sp:
  buffer_store_dwordx2 v[8:9], v11, s[32:35], s38 offen sc1
  s_branch L_c_spd
L_c_slow:
  s_mov_b64 s[54:55], exec
  s_mov_b64 exec, vcc
  v_cmp_eq_u32 s[52:53], 0, v4
  s_mov_b32 s60, 1115684864
  s_mov_b32 s61, 0
  v_cndmask_b32 v4, v4, 32, s[52:53]
  v_cndmask_b32 v66, v6, 0, s[52:53]
L_c_slow_o:
  v_mov_b32 v67, 0
  v_mov_b32 v68, 0
  s_mov_b32 s62, s37
  s_mov_b32 s63, 0
L_c_slow_l:
  buffer_load_dwordx2 v[70:71], v11, s[32:35], s62 offen sc1
  s_add_u32 s62, s62, 512
  s_add_u32 s63, s63, 1
  s_waitcnt vmcnt(0)
  v_cmp_ngt_f32 s[56:57], s60, |v70|
  v_cmp_eq_u32 vcc, s18, v71
  s_or_b64 s[56:57], s[56:57], s[52:53]
  s_and_b64 vcc, vcc, s[56:57]
  s_cmp_lt_u32 s63, 32
  v_cndmask_b32 v72, 0, v70, vcc
  v_cndmask_b32 v73, 0, 1, vcc
  v_add_f32 v67, v67, v72
  v_add_u32 v68, v68, v73
  s_cbranch_scc1 L_c_slow_l
  v_add_f32 v6, v66, v67
  v_cmp_ne_u32 vcc, v68, v4
  s_add_u32 s61, s61, 1
  s_and_b64 exec, exec, vcc
  s_cbranch_scc0 L_c_slow_e
  s_cmp_lt_u32 s61, 4096
  s_cbranch_scc1 L_c_slow_o
L_c_slow_e:
  s_mov_b32 s60, 0x35800000
  s_mov_b64 exec, s[54:55]
  s_branch L_c_out
L_c_glob:
  buffer_store_dwordx2 v[68:69], v12, s[32:35], s49 offen sc1
  s_mov_b64 exec, -1
  s_cmp_ge_u32 s5, 28
  s_cbranch_scc1 L_c_fin
  s_mov_b32 s61, 0
L_c_rem:
  s_barrier
  ds_read_b64_tr_b16 v[72:73], v15
  ds_read_b64_tr_b16 v[74:75], v15 offset:512
  ds_read_b64_tr_b16 v[76:77], v16
  ds_read_b64_tr_b16 v[78:79], v16 offset:512
  ds_read_b64_tr_b16 v[80:81], v17
  ds_read_b64_tr_b16 v[82:83], v17 offset:512
  ds_read_b64_tr_b16 v[84:85], v18
  ds_read_b64_tr_b16 v[86:87], v18 offset:512
G_23:
  s_add_u32 s61, s61, 1
  s_cmp_ge_u32 s61, 131072
  s_cbranch_scc1 GD_24
  s_and_b32 s60, s61, s58
  s_cbranch_scc1 NG_25
  buffer_load_dwordx4 v[88:91], v13, s[32:35], s55 offen sc1
  buffer_load_dwordx4 v[92:95], v13, s[32:35], s55 offen offset:16 sc1
  s_branch NG_25_c
NG_25:
  buffer_load_dwordx4 v[88:91], v96, s[32:35], s57 offen sc1
  buffer_load_dwordx4 v[92:95], v96, s[32:35], s57 offen offset:256 sc1
NG_25_c:
  s_mov_b64 s[52:53], exec
  s_mov_b64 exec, -1
  ds_read_b32 v10, v2 offset:84
  ds_read_b128 v[64:67], v19
  s_mov_b64 exec, s[52:53]
  s_waitcnt vmcnt(0)
  v_xor_b32 v4, s18, v89
  v_xor_b32 v5, s18, v91
  v_or_b32 v4, v4, v5
  v_xor_b32 v5, s18, v93
  v_or_b32 v4, v4, v5
  v_xor_b32 v5, s18, v95
  v_or_b32 v4, v4, v5
  v_cmp_ne_u32 vcc, 0, v4
  s_cbranch_vccz GD_24
  s_mov_b64 exec, vcc
  s_bcnt1_i32_b64 s60, vcc
  s_cmp_le_u32 s60, 32
  s_cbranch_scc1 G_23
  s_sleep 3
  s_branch G_23
GD_24:
  s_mov_b64 exec, -1
  v_mov_b32 v89, v90
  v_mov_b32 v90, v92
  v_mov_b32 v91, v94
  s_branch L_pp_d
L_xwave:
  s_branch L_x12
L_x0e:
  s_load_dword s18, s[30:31], 0
  s_mov_b32 s32, s30
  s_mov_b32 s33, s31
  s_mov_b32 s34, 4194304
  s_mov_b32 s35, 0x20000
  v_and_b32 v5, 31, v1
  v_add_u32 v20, 151552, v20
  v_cmp_gt_u32 s[40:41], 28, v5
  v_lshlrev_b32 v6, 3, v1
  v_mov_b32 v8, 0
  v_mov_b32 v9, 0
  v_add_u32 v6, 153344, v6
  s_mov_b64 exec, 15
  ds_write_b64 v6, v[8:9]
  s_mov_b64 exec, -1
  s_mov_b32 s42, 0x3B124925
  s_waitcnt vmcnt(0)
  v_lshlrev_b32 v32, 16, v24
  v_and_b32 v33, 0xffff0000, v24
  v_lshlrev_b32 v34, 16, v25
  v_and_b32 v35, 0xffff0000, v25
  v_lshlrev_b32 v36, 16, v26
  v_and_b32 v37, 0xffff0000, v26
  v_lshlrev_b32 v38, 16, v27
  v_and_b32 v39, 0xffff0000, v27
  v_lshlrev_b32 v40, 16, v28
  v_and_b32 v41, 0xffff0000, v28
  v_lshlrev_b32 v42, 16, v29
  v_and_b32 v43, 0xffff0000, v29
  v_lshlrev_b32 v44, 16, v30
  v_and_b32 v45, 0xffff0000, v30
  v_lshlrev_b32 v46, 16, v31
  v_and_b32 v47, 0xffff0000, v31
  v_add_f32 v6, v32, v33
  v_add_f32 v7, v34, v35
  v_add_f32 v6, v6, v36
  v_add_f32 v6, v6, v37
  v_add_f32 v7, v7, v38
  v_add_f32 v7, v7, v39
  v_add_f32 v6, v6, v40
  v_add_f32 v6, v6, v41
  v_add_f32 v7, v7, v42
  v_add_f32 v7, v7, v43
  v_add_f32 v6, v6, v44
  v_add_f32 v6, v6, v45
  v_add_f32 v7, v7, v46
  v_add_f32 v7, v7, v47
  v_add_f32 v6, v6, v7
  v_cndmask_b32 v6, 0, v6, s[40:41]
  s_nop 1
  v_add_f32_dpp v6, v6, v6 row_ror:8 row_mask:0xf bank_mask:0xf
  s_nop 1
  v_add_f32_dpp v6, v6, v6 row_ror:4 row_mask:0xf bank_mask:0xf
  s_nop 1
  v_add_f32_dpp v6, v6, v6 row_ror:2 row_mask:0xf bank_mask:0xf
  s_nop 1
  v_add_f32_dpp v6, v6, v6 row_ror:1 row_mask:0xf bank_mask:0xf
  v_mov_b32 v5, v6
  s_nop 1
  v_permlane16_swap_b32 v5, v6
  s_nop 0
  v_add_f32 v6, v6, v5
  v_mul_f32 v6, s42, v6
  v_mov_b32 v7, 0
  v_mov_b32 v8, 0
  v_sub_f32 v9, v32, v6
  v_fmac_f32 v7, v9, v9
  v_sub_f32 v9, v33, v6
  v_fmac_f32 v8, v9, v9
  v_sub_f32 v9, v34, v6
  v_fmac_f32 v7, v9, v9
  v_sub_f32 v9, v35, v6
  v_fmac_f32 v8, v9, v9
  v_sub_f32 v9, v36, v6
  v_fmac_f32 v7, v9, v9
  v_sub_f32 v9, v37, v6
  v_fmac_f32 v8, v9, v9
  v_sub_f32 v9, v38, v6
  v_fmac_f32 v7, v9, v9
  v_sub_f32 v9, v39, v6
  v_fmac_f32 v8, v9, v9
  v_sub_f32 v9, v40, v6
  v_fmac_f32 v7, v9, v9
  v_sub_f32 v9, v41, v6
  v_fmac_f32 v8, v9, v9
  v_sub_f32 v9, v42, v6
  v_fmac_f32 v7, v9, v9
  v_sub_f32 v9, v43, v6
  v_fmac_f32 v8, v9, v9
  v_sub_f32 v9, v44, v6
  v_fmac_f32 v7, v9, v9
  v_sub_f32 v9, v45, v6
  v_fmac_f32 v8, v9, v9
  v_sub_f32 v9, v46, v6
  v_fmac_f32 v7, v9, v9
  v_sub_f32 v9, v47, v6
  v_fmac_f32 v8, v9, v9
  v_add_f32 v7, v7, v8
  v_cndmask_b32 v7, 0, v7, s[40:41]
  s_nop 1
  v_add_f32_dpp v7, v7, v7 row_ror:8 row_mask:0xf bank_mask:0xf
  s_nop 1
  v_add_f32_dpp v7, v7, v7 row_ror:4 row_mask:0xf bank_mask:0xf
  s_nop 1
  v_add_f32_dpp v7, v7, v7 row_ror:2 row_mask:0xf bank_mask:0xf
  s_nop 1
  v_add_f32_dpp v7, v7, v7 row_ror:1 row_mask:0xf bank_mask:0xf
  v_mov_b32 v5, v7
  s_nop 1
  v_permlane16_swap_b32 v5, v7
  s_nop 0
  v_add_f32 v7, v7, v5
  v_mul_f32 v7, s42, v7
  v_cvt_pk_bf16_f32 v6, v6, v6
  v_lshlrev_b32 v6, 16, v6
  v_cvt_pk_bf16_f32 v7, v7, v7
  v_lshlrev_b32 v7, 16, v7
  v_add_f32 v7, 0x3727C5AC, v7
  v_cvt_pk_bf16_f32 v7, v7, v7
  v_lshlrev_b32 v7, 16, v7
  v_sqrt_f32 v7, v7
  s_nop 0
  v_cvt_pk_bf16_f32 v7, v7, v7
  v_lshlrev_b32 v7, 16, v7
  v_rcp_f32 v7, v7
  v_sub_f32 v32, v32, v6
  v_sub_f32 v33, v33, v6
  v_sub_f32 v34, v34, v6
  v_sub_f32 v35, v35, v6
  v_sub_f32 v36, v36, v6
  v_sub_f32 v37, v37, v6
  v_sub_f32 v38, v38, v6
  v_sub_f32 v39, v39, v6
  v_sub_f32 v40, v40, v6
  v_sub_f32 v41, v41, v6
  v_sub_f32 v42, v42, v6
  v_sub_f32 v43, v43, v6
  v_sub_f32 v44, v44, v6
  v_sub_f32 v45, v45, v6
  v_sub_f32 v46, v46, v6
  v_sub_f32 v47, v47, v6
  v_cvt_pk_bf16_f32 v24, v32, v33
  v_cvt_pk_bf16_f32 v25, v34, v35
  v_cvt_pk_bf16_f32 v26, v36, v37
  v_cvt_pk_bf16_f32 v27, v38, v39
  v_cvt_pk_bf16_f32 v28, v40, v41
  v_cvt_pk_bf16_f32 v29, v42, v43
  v_cvt_pk_bf16_f32 v30, v44, v45
  v_cvt_pk_bf16_f32 v31, v46, v47
  v_lshlrev_b32 v32, 16, v24
  v_and_b32 v33, 0xffff0000, v24
  v_lshlrev_b32 v34, 16, v25
  v_and_b32 v35, 0xffff0000, v25
  v_lshlrev_b32 v36, 16, v26
  v_and_b32 v37, 0xffff0000, v26
  v_lshlrev_b32 v38, 16, v27
  v_and_b32 v39, 0xffff0000, v27
  v_lshlrev_b32 v40, 16, v28
  v_and_b32 v41, 0xffff0000, v28
  v_lshlrev_b32 v42, 16, v29
  v_and_b32 v43, 0xffff0000, v29
  v_lshlrev_b32 v44, 16, v30
  v_and_b32 v45, 0xffff0000, v30
  v_lshlrev_b32 v46, 16, v31
  v_and_b32 v47, 0xffff0000, v31
  v_mul_f32 v32, v32, v7
  v_mul_f32 v33, v33, v7
  v_mul_f32 v34, v34, v7
  v_mul_f32 v35, v35, v7
  v_mul_f32 v36, v36, v7
  v_mul_f32 v37, v37, v7
  v_mul_f32 v38, v38, v7
  v_mul_f32 v39, v39, v7
  v_mul_f32 v40, v40, v7
  v_mul_f32 v41, v41, v7
  v_mul_f32 v42, v42, v7
  v_mul_f32 v43, v43, v7
  v_mul_f32 v44, v44, v7
  v_mul_f32 v45, v45, v7
  v_mul_f32 v46, v46, v7
  v_mul_f32 v47, v47, v7
  v_cvt_pk_bf16_f32 v24, v32, v33
  v_cvt_pk_bf16_f32 v25, v34, v35
  v_cvt_pk_bf16_f32 v26, v36, v37
  v_cvt_pk_bf16_f32 v27, v38, v39
  v_cvt_pk_bf16_f32 v28, v40, v41
  v_cvt_pk_bf16_f32 v29, v42, v43
  v_cvt_pk_bf16_f32 v30, v44, v45
  v_cvt_pk_bf16_f32 v31, v46, v47
  s_mov_b64 exec, s[40:41]
  ds_write_b128 v20, v[24:27]
  ds_write_b128 v20, v[28:31] offset:16
  s_mov_b64 exec, -1
  s_waitcnt lgkmcnt(0)
  s_mov_b64 exec, 1
  ds_add_u32 v2, v3 offset:64
  s_mov_b64 exec, -1
  s_waitcnt lgkmcnt(0)
  s_mul_i32 s18, s18, 0x9E3779B1
  s_add_u32 s18, s18, 0x7F4A7C15
  v_and_b32 v4, 1, v1
  v_lshlrev_b32 v21, 4, v4
  v_add_u32 v20, 154112, v21
  s_mov_b32 s45, 1035512379
  s_lshl_b32 s60, s4, 10
  s_add_u32 s46, s60, 262144
  s_lshl_b32 s60, s6, 4
  s_add_u32 s60, s60, s7
  s_lshl_b32 s60, s60, 5
  s_add_u32 s44, s46, s60
  v_lshlrev_b32 v22, 4, v1
  v_lshrrev_b32 v5, 5, v1
  v_lshl_or_b32 v5, v5, 1, v4
  v_lshlrev_b32 v23, 6, v5
  v_bfe_u32 v5, v1, 1, 4
  v_lshl_add_u32 v23, v5, 2, v23
  v_add_u32 v23, 154368, v23
  v_mov_b32 v9, s18
  v_mov_b32 v11, s18
  s_mov_b32 s63, 0
W_31:
  ds_read_b32 v4, v2 offset:76
  s_add_u32 s63, s63, 1
  s_waitcnt lgkmcnt(0)
  v_readfirstlane_b32 s60, v4
  s_cmp_ge_u32 s60, 4
  s_cbranch_scc1 D_32
  s_sleep 1
  s_cmp_lt_u32 s63, 131072
  s_cbranch_scc1 W_31
D_32:
  ds_read_b32 v12, v2 offset:96
  ds_read_b128 v[24:27], v20
  ds_read_b128 v[28:31], v20 offset:32
  s_waitcnt lgkmcnt(0)
  v_readfirstlane_b32 s59, v12
  v_max3_f32 v8, v24, v25, v26
  v_max_f32 v8, v8, v27
  v_mul_f32 v5, s45, v8
  v_fma_f32 v24, v24, s45, -v5
  v_fma_f32 v25, v25, s45, -v5
  v_fma_f32 v26, v26, s45, -v5
  v_fma_f32 v27, v27, s45, -v5
  v_exp_f32 v24, v24
  v_exp_f32 v25, v25
  v_exp_f32 v26, v26
  v_exp_f32 v27, v27
  s_nop 0
  v_mul_f32 v10, v24, v28
  v_fmac_f32 v10, v25, v29
  v_fmac_f32 v10, v26, v30
  v_fmac_f32 v10, v27, v31
  s_mov_b64 exec, 3
  s_add_u32 s49, s44, 2097152
  buffer_store_dwordx4 v[8:11], v21, s[32:35], s44 offen
  s_cmp_eq_u32 s59, 0
  s_cbranch_scc1 L_x0_noglob
  buffer_store_dwordx4 v[8:11], v21, s[32:35], s49 offen sc1
L_x0_noglob:
  s_mov_b64 exec, -1
  s_cmp_ge_u32 s5, 28
  s_cbranch_scc1 L_x0_end
  s_lshr_b32 s60, s5, 2
  s_lshl_b32 s60, s60, 3
  s_add_u32 s47, s60, 1105920
  buffer_load_dwordx2 v[32:33], off, s[32:35], s47 sc1
  s_mov_b32 s63, 0
W_33:
  ds_read_b32 v4, v2 offset:44
  s_add_u32 s63, s63, 1
  s_waitcnt lgkmcnt(0)
  v_readfirstlane_b32 s60, v4
  s_cmp_ge_u32 s60, 4
  s_cbranch_scc1 D_34
  s_sleep 2
  s_cmp_lt_u32 s63, 131072
  s_cbranch_scc1 W_33
D_34:
  s_cmp_eq_u32 s59, 0
  s_cselect_b32 s60, 0, 2097152
  s_add_u32 s46, s46, s60
  buffer_load_dwordx4 v[24:27], v22, s[32:35], s46 offen sc1
  s_mov_b32 s63, 0
W_35:
  ds_read_b32 v4, v2 offset:48
  s_add_u32 s63, s63, 1
  s_waitcnt lgkmcnt(0)
  v_readfirstlane_b32 s60, v4
  s_cmp_ge_u32 s60, 4
  s_cbranch_scc1 D_36
  s_sleep 1
  s_cmp_lt_u32 s63, 131072
  s_cbranch_scc1 W_35
D_36:
  buffer_load_dwordx4 v[28:31], v22, s[32:35], s46 offen sc1
  s_barrier
  s_waitcnt vmcnt(1)
  v_xor_b32 v4, s18, v25
  v_xor_b32 v5, s18, v27
  v_or_b32 v4, v4, v5
  v_cmp_ne_u32 vcc, 0, v4
  s_cbranch_vccz L_ml_d
  s_mov_b32 s61, 0
L_ml_l:
  s_mov_b64 exec, vcc
  s_waitcnt vmcnt(0)
  v_mov_b32 v24, v28
  v_mov_b32 v26, v30
  v_xor_b32 v4, s18, v29
  v_xor_b32 v5, s18, v31
  v_or_b32 v4, v4, v5
  v_cmp_ne_u32 vcc, 0, v4
  s_cbranch_vccz L_ml_d
  s_mov_b64 exec, vcc
  s_sleep 1
  buffer_load_dwordx4 v[28:31], v22, s[32:35], s46 offen sc1
  s_add_u32 s61, s61, 1
  s_cmp_lt_u32 s61, 131072
  s_cbranch_scc1 L_ml_l
L_ml_d:
  s_mov_b64 exec, -1
  v_mov_b32 v8, v24
  s_nop 1
  v_max_f32_dpp v8, v8, v8 row_ror:2 row_mask:0xf bank_mask:0xf
  s_nop 1
  v_max_f32_dpp v8, v8, v8 row_ror:4 row_mask:0xf bank_mask:0xf
  s_nop 1
  v_max_f32_dpp v8, v8, v8 row_ror:8 row_mask:0xf bank_mask:0xf
  v_mov_b32 v5, v8
  s_nop 1
  v_permlane16_swap_b32 v5, v8
  s_nop 0
  v_max_f32 v8, v8, v5
  v_sub_f32 v8, v24, v8
  v_mul_f32 v8, s45, v8
  v_exp_f32 v8, v8
  s_nop 0
  v_mul_f32 v9, v8, v26
  s_nop 1
  v_add_f32_dpp v9, v9, v9 row_ror:2 row_mask:0xf bank_mask:0xf
  s_nop 1
  v_add_f32_dpp v9, v9, v9 row_ror:4 row_mask:0xf bank_mask:0xf
  s_nop 1
  v_add_f32_dpp v9, v9, v9 row_ror:8 row_mask:0xf bank_mask:0xf
  v_mov_b32 v5, v9
  s_nop 1
  v_permlane16_swap_b32 v5, v9
  s_nop 0
  v_add_f32 v9, v9, v5
  v_rcp_f32 v9, v9
  s_nop 0
  v_mul_f32 v8, v8, v9
  ds_write_b32 v23, v8
  s_mov_b32 s61, 0
L_x0_zl:
  v_xor_b32 v4, s18, v32
  v_xor_b32 v5, s18, v33
  v_or_b32 v4, v4, v5
  v_cmp_ne_u32 vcc, 0, v4
  s_cbranch_vccz L_x0_zd
  s_sleep 4
  buffer_load_dwordx2 v[32:33], off, s[32:35], s47 sc1
  s_add_u32 s61, s61, 1
  s_cmp_lt_u32 s61, 131072
  s_waitcnt vmcnt(0)
  s_cbranch_scc1 L_x0_zl
L_x0_zd:
  s_mov_b64 exec, 1
  ds_add_u32 v2, v3 offset:84
  s_mov_b64 exec, -1
L_x0_end:
  s_endpgm
L_x12:
  s_cmp_eq_u32 s3, 14
  s_cbranch_scc1 L_tt1
L_tt_r:
  s_waitcnt lgkmcnt(0)
  s_mul_i32 s18, s18, 0x9E3779B1
  s_add_u32 s18, s18, 0x7F4A7C15
  s_sub_u32 s40, s3, 13
  v_lshlrev_b32 v21, 3, v1
  s_cmp_ge_u32 s99, 98
  s_cbranch_scc1 L_x12_g
  s_cmp_lg_u32 s100, 0
  s_cbranch_scc1 L_x12_ni
  v_lshrrev_b32 v4, 5, v1
  v_bfe_u32 v5, v1, 3, 2
  v_lshl_add_u32 v4, v4, 3, v5
  v_mul_u32_u24 v4, 64, v4
  v_and_b32 v5, 7, v1
  v_lshl_add_u32 v4, v5, 3, v4
  s_mul_i32 s60, s101, 1024
  s_mul_i32 s61, s40, 256
  s_add_u32 s60, s60, s61
  s_add_u32 s60, s60, 1097728
  v_mov_b32 v6, 0
  v_mov_b32 v7, 0
  buffer_store_dwordx2 v[6:7], v4, s[32:35], s60 offen sc1
  s_lshl_b32 s60, s101, 3
  s_lshl_b32 s61, s40, 2
  s_add_u32 s60, s60, s61
  s_add_u32 s60, s60, 1105920
  v_mov_b32 v6, s18
  s_mov_b64 exec, 1
  s_waitcnt vmcnt(0)
  buffer_store_dword v6, off, s[32:35], s60 sc1
  s_mov_b64 exec, -1
L_x12_ni:
  s_lshl_b32 s41, s100, 1
  s_add_u32 s41, s41, s40
  v_lshrrev_b32 v5, 4, v1
  v_and_b32 v4, 7, v1
  v_lshl_add_u32 v5, v5, 3, v4
  v_lshlrev_b32 v20, 2, v5
  s_lshl_b32 s60, s41, 7
  v_add_u32 v6, s60, v20
  global_load_dword v40, v6, s[22:23]
  s_lshl_b32 s60, s41, 11
  s_add_u32 s44, s60, 2293760
  v_bfe_u32 v4, v1, 3, 1
  v_lshl_add_u32 v20, v4, 8, v20
  s_lshl_b32 s60, s40, 7
  s_add_u32 s60, s60, 154624
  v_add_u32 v20, s60, v20
  v_and_b32 v4, 1, v1
  v_lshrrev_b32 v5, 4, v1
  v_lshlrev_b32 v22, 8, v4
  v_lshl_add_u32 v22, v5, 4, v22
  v_add_u32 v22, 154624, v22
  s_lshl_b32 s42, s40, 1
  s_mul_i32 s60, s101, 7168
  s_lshl_b32 s61, s100, 9
  s_add_u32 s60, s60, s61
  s_lshl_b32 s61, s40, 8
  s_add_u32 s60, s60, s61
  s_add_u32 s46, s60, 1114112
  v_bfe_u32 v18, v1, 4, 1
  v_lshlrev_b32 v18, 7, v18
  v_lshl_add_u32 v18, v4, 6, v18
  v_bfe_u32 v5, v1, 1, 3
  v_lshl_add_u32 v18, v5, 3, v18
  v_lshrrev_b32 v4, 4, v1
  v_bfe_u32 v5, v1, 2, 2
  v_lshl_add_u32 v6, v4, 3, v5
  v_lshlrev_b32 v23, 7, v6
  v_lshrrev_b32 v5, 1, v5
  v_and_b32 v4, 1, v4
  v_lshl_or_b32 v5, v4, 1, v5
  v_xor_b32 v5, s42, v5
  v_lshl_add_u32 v23, v5, 5, v23
  v_and_b32 v5, 3, v1
  v_lshl_add_u32 v23, v5, 3, v23
  v_add_u32 v23, 131072, v23
  v_xor_b32 v19, 32, v23
  s_mov_b32 s63, 0
W_37:
  ds_read_b32 v4, v2 offset:20
  s_add_u32 s63, s63, 1
  s_waitcnt lgkmcnt(0)
  v_readfirstlane_b32 s60, v4
  s_cmp_ge_u32 s60, 4
  s_cbranch_scc1 D_38
  s_sleep 1
  s_cmp_lt_u32 s63, 131072
  s_cbranch_scc1 W_37
D_38:
  ds_read_b64_tr_b16 v[48:49], v23 offset:0
  ds_read_b64_tr_b16 v[50:51], v23 offset:512
  ds_read_b64_tr_b16 v[52:53], v19 offset:0
  ds_read_b64_tr_b16 v[54:55], v19 offset:512
  ds_read_b64_tr_b16 v[56:57], v23 offset:4096
  ds_read_b64_tr_b16 v[58:59], v23 offset:4608
  ds_read_b64_tr_b16 v[60:61], v19 offset:4096
  ds_read_b64_tr_b16 v[62:63], v19 offset:4608
  s_waitcnt lgkmcnt(0)
  ds_read_b64_tr_b16 v[64:65], v23 offset:8192
  ds_read_b64_tr_b16 v[66:67], v23 offset:8704
  ds_read_b64_tr_b16 v[68:69], v19 offset:8192
  ds_read_b64_tr_b16 v[70:71], v19 offset:8704
  ds_read_b64_tr_b16 v[72:73], v23 offset:12288
  ds_read_b64_tr_b16 v[74:75], v23 offset:12800
  ds_read_b64_tr_b16 v[76:77], v19 offset:12288
  ds_read_b64_tr_b16 v[78:79], v19 offset:12800
  v_mov_b32 v5, 2
  s_waitcnt lgkmcnt(0)
  s_mov_b64 exec, 1
  ds_add_u32 v2, v5 offset:92
  s_mov_b64 exec, -1
  s_mov_b32 s63, 0
W_39:
  ds_read_b32 v4, v2 offset:36
  s_add_u32 s63, s63, 1
  s_waitcnt lgkmcnt(0)
  v_readfirstlane_b32 s60, v4
  s_cmp_ge_u32 s60, 4
  s_cbranch_scc1 D_40
  s_sleep 4
  s_cmp_lt_u32 s63, 131072
  s_cbranch_scc1 W_39
D_40:
  s_mov_b32 s61, 0
G_41:
  buffer_load_dwordx2 v[24:25], v21, s[32:35], s44 offen offset:0 sc1
  buffer_load_dwordx2 v[26:27], v21, s[32:35], s44 offen offset:512 sc1
  buffer_load_dwordx2 v[28:29], v21, s[32:35], s44 offen offset:1024 sc1
  buffer_load_dwordx2 v[30:31], v21, s[32:35], s44 offen offset:1536 sc1
  s_add_u32 s61, s61, 1
  s_cmp_ge_u32 s61, 131072
  s_waitcnt vmcnt(0)
  s_cbranch_scc1 GD_42
  v_xor_b32 v4, s18, v25
  v_xor_b32 v5, s18, v27
  v_or_b32 v4, v4, v5
  v_xor_b32 v5, s18, v29
  v_or_b32 v4, v4, v5
  v_xor_b32 v5, s18, v31
  v_or_b32 v4, v4, v5
  v_cmp_ne_u32 vcc, 0, v4
  s_cbranch_vccz GD_42
  s_sleep 8
  s_branch G_41
GD_42:
  v_lshlrev_b32 v6, 16, v24
  v_and_b32 v7, 0xffff0000, v24
  v_lshlrev_b32 v8, 16, v26
  v_and_b32 v9, 0xffff0000, v26
  v_add_f32 v6, v6, v8
  v_add_f32 v7, v7, v9
  v_lshlrev_b32 v8, 16, v28
  v_and_b32 v9, 0xffff0000, v28
  v_add_f32 v6, v6, v8
  v_add_f32 v7, v7, v9
  v_lshlrev_b32 v8, 16, v30
  v_and_b32 v9, 0xffff0000, v30
  v_add_f32 v6, v6, v8
  v_add_f32 v7, v7, v9
  v_cvt_pk_bf16_f32 v6, v6, v7
  v_and_b32 v7, 0xffff0000, v6
  v_lshlrev_b32 v6, 16, v6
  v_lshlrev_b32 v8, 16, v40
  v_and_b32 v9, 0xffff0000, v40
  v_add_f32 v6, v6, v8
  v_add_f32 v7, v7, v9
  v_cvt_pk_bf16_f32 v6, v6, v7
  v_and_b32 v7, 0xffff0000, v6
  v_lshlrev_b32 v6, 16, v6
  v_max_f32 v6, 0, v6
  v_max_f32 v7, 0, v7
  v_mul_f32 v6, v6, v6
  v_mul_f32 v7, v7, v7
  v_cvt_pk_bf16_f32 v6, v6, v7
  ds_write_b32 v20, v6
  s_waitcnt lgkmcnt(0)
  s_mov_b64 exec, 1
  ds_add_u32 v2, v3 offset:80
  s_mov_b64 exec, -1
  s_mov_b32 s63, 0
W_43:
  ds_read_b32 v4, v2 offset:80
  s_add_u32 s63, s63, 1
  s_waitcnt lgkmcnt(0)
  v_readfirstlane_b32 s60, v4
  s_cmp_ge_u32 s60, 2
  s_cbranch_scc1 D_44
  s_sleep 1
  s_cmp_lt_u32 s63, 131072
  s_cbranch_scc1 W_43
D_44:
  ds_read_b128 v[24:27], v22 offset:0
  ds_read_b128 v[28:31], v22 offset:64
  ds_read_b128 v[32:35], v22 offset:128
  ds_read_b128 v[36:39], v22 offset:192
  s_waitcnt lgkmcnt(3)
  v_mfma_f32_16x16x32_bf16 v[80:83], v[24:27], v[48:51], 0
  v_mfma_f32_16x16x32_bf16 v[84:87], v[24:27], v[52:55], 0
  s_waitcnt lgkmcnt(2)
  v_mfma_f32_16x16x32_bf16 v[80:83], v[28:31], v[56:59], v[80:83]
  v_mfma_f32_16x16x32_bf16 v[84:87], v[28:31], v[60:63], v[84:87]
  s_waitcnt lgkmcnt(1)
  v_mfma_f32_16x16x32_bf16 v[80:83], v[32:35], v[64:67], v[80:83]
  v_mfma_f32_16x16x32_bf16 v[84:87], v[32:35], v[68:71], v[84:87]
  s_waitcnt lgkmcnt(0)
  v_mfma_f32_16x16x32_bf16 v[80:83], v[36:39], v[72:75], v[80:83]
  v_mfma_f32_16x16x32_bf16 v[84:87], v[36:39], v[76:79], v[84:87]
  v_mov_b32 v9, s18
  v_and_b32 v4, 1, v1
  s_mov_b32 s52, 0xffff0000
  s_mov_b32 s53, s52
  v_cmp_eq_u32 vcc, 0, v4
  s_nop 2
  v_cndmask_b32 v10, v80, v84, s[52:53]
  v_cndmask_b32 v11, v81, v85, s[52:53]
  s_nop 1
  v_mov_b32_dpp v6, v10 quad_perm:[1,0,3,2] row_mask:0xf bank_mask:0xf
  v_mov_b32_dpp v7, v11 quad_perm:[1,0,3,2] row_mask:0xf bank_mask:0xf
  v_cndmask_b32 v4, v7, v10, vcc
  v_cndmask_b32 v5, v11, v6, vcc
  v_cvt_pk_bf16_f32 v8, v4, v5
  s_mov_b32 exec_hi, 0
  v_mov_b32 v11, v9
  v_mov_b32_dpp v10, v8 quad_perm:[2,3,2,3] row_mask:0xf bank_mask:0xf
  s_mov_b32 exec_lo, 0x33333333
  buffer_store_dwordx4 v[8:11], v18, s[32:35], s46 offen sc1
  s_mov_b64 exec, -1
L_x12_g:
  s_sub_u32 s43, s5, 28
  s_lshl_b32 s43, s43, 1
  s_add_u32 s43, s43, s40
  s_cmp_ge_u32 s43, 7
  s_cbranch_scc1 L_x12_end
  v_and_b32 v5, 31, v1
  v_lshrrev_b32 v4, 5, v1
  v_lshlrev_b32 v103, 4, v5
  v_lshl_add_u32 v103, v4, 9, v103
  v_lshl_or_b32 v5, v5, 1, v4
  v_lshrrev_b32 v4, 4, v5
  v_and_b32 v6, 7, v5
  v_lshl_add_u32 v4, v4, 3, v6
  s_lshl_b32 s60, s43, 7
  v_lshl_add_u32 v6, v4, 2, s60
  global_load_dword v100, v6, s[26:27]
  v_bfe_u32 v5, v5, 3, 1
  v_lshlrev_b32 v102, 3, v4
  v_lshl_add_u32 v102, v5, 8, v102
  s_mul_i32 s60, s43, 7168
  s_add_u32 s44, s60, 1114112
  s_add_u32 s45, s44, 4096
  s_lshl_b32 s60, s4, 3
  s_add_u32 s60, s60, s43
  s_lshl_b32 s60, s60, 9
  s_add_u32 s46, s60, 1179648
  s_add_u32 s47, s46, 2097152
  s_mov_b32 s61, 0
  s_mov_b32 s63, 0
W_45:
  ds_read_b32 v4, v2 offset:72
  s_add_u32 s63, s63, 1
  s_waitcnt lgkmcnt(0)
  v_readfirstlane_b32 s60, v4
  s_cmp_ge_u32 s60, 8
  s_cbranch_scc1 D_46
  s_sleep 4
  s_cmp_lt_u32 s63, 131072
  s_cbranch_scc1 W_45
D_46:
  s_mov_b32 s63, 0
W_47:
  ds_read_b32 v4, v2 offset:48
  s_add_u32 s63, s63, 1
  s_waitcnt lgkmcnt(0)
  v_readfirstlane_b32 s60, v4
  s_cmp_ge_u32 s60, 4
  s_cbranch_scc1 D_48
  s_sleep 2
  s_cmp_lt_u32 s63, 131072
  s_cbranch_scc1 W_47
D_48:
  ds_read_b32 v12, v2 offset:96
G_49:
  buffer_load_dwordx4 v[24:27], v103, s[32:35], s44 offen offset:0 sc1
  buffer_load_dwordx4 v[28:31], v103, s[32:35], s44 offen offset:1024 sc1
  buffer_load_dwordx4 v[32:35], v103, s[32:35], s44 offen offset:2048 sc1
  buffer_load_dwordx4 v[36:39], v103, s[32:35], s44 offen offset:3072 sc1
  buffer_load_dwordx4 v[40:43], v103, s[32:35], s45 offen offset:0 sc1
  buffer_load_dwordx4 v[44:47], v103, s[32:35], s45 offen offset:1024 sc1
  buffer_load_dwordx4 v[48:51], v103, s[32:35], s45 offen offset:2048 sc1
  s_add_u32 s61, s61, 1
  s_cmp_ge_u32 s61, 131072
  s_waitcnt vmcnt(0)
  s_cbranch_scc1 GD_50
  v_xor_b32 v4, s18, v25
  v_xor_b32 v5, s18, v27
  v_or_b32 v4, v4, v5
  v_xor_b32 v5, s18, v29
  v_or_b32 v4, v4, v5
  v_xor_b32 v5, s18, v31
  v_or_b32 v4, v4, v5
  v_xor_b32 v5, s18, v33
  v_or_b32 v4, v4, v5
  v_xor_b32 v5, s18, v35
  v_or_b32 v4, v4, v5
  v_xor_b32 v5, s18, v37
  v_or_b32 v4, v4, v5
  v_xor_b32 v5, s18, v39
  v_or_b32 v4, v4, v5
  v_xor_b32 v5, s18, v41
  v_or_b32 v4, v4, v5
  v_xor_b32 v5, s18, v43
  v_or_b32 v4, v4, v5
  v_xor_b32 v5, s18, v45
  v_or_b32 v4, v4, v5
  v_xor_b32 v5, s18, v47
  v_or_b32 v4, v4, v5
  v_xor_b32 v5, s18, v49
  v_or_b32 v4, v4, v5
  v_xor_b32 v5, s18, v51
  v_or_b32 v4, v4, v5
  v_cmp_ne_u32 vcc, 0, v4
  s_cbranch_vccz GD_50
  s_mov_b64 exec, vcc
  s_sleep 4
  s_branch G_49
GD_50:
  s_mov_b64 exec, -1
  v_lshlrev_b32 v6, 16, v24
  v_and_b32 v7, 0xffff0000, v24
  v_lshlrev_b32 v8, 16, v26
  v_and_b32 v9, 0xffff0000, v26
  v_lshlrev_b32 v4, 16, v28
  v_and_b32 v5, 0xffff0000, v28
  v_lshlrev_b32 v10, 16, v30
  v_and_b32 v11, 0xffff0000, v30
  v_add_f32 v6, v6, v4
  v_add_f32 v7, v7, v5
  v_add_f32 v8, v8, v10
  v_add_f32 v9, v9, v11
  v_lshlrev_b32 v4, 16, v32
  v_and_b32 v5, 0xffff0000, v32
  v_lshlrev_b32 v10, 16, v34
  v_and_b32 v11, 0xffff0000, v34
  v_add_f32 v6, v6, v4
  v_add_f32 v7, v7, v5
  v_add_f32 v8, v8, v10
  v_add_f32 v9, v9, v11
  v_lshlrev_b32 v4, 16, v36
  v_and_b32 v5, 0xffff0000, v36
  v_lshlrev_b32 v10, 16, v38
  v_and_b32 v11, 0xffff0000, v38
  v_add_f32 v6, v6, v4
  v_add_f32 v7, v7, v5
  v_add_f32 v8, v8, v10
  v_add_f32 v9, v9, v11
  v_lshlrev_b32 v4, 16, v40
  v_and_b32 v5, 0xffff0000, v40
  v_lshlrev_b32 v10, 16, v42
  v_and_b32 v11, 0xffff0000, v42
  v_add_f32 v6, v6, v4
  v_add_f32 v7, v7, v5
  v_add_f32 v8, v8, v10
  v_add_f32 v9, v9, v11
  v_lshlrev_b32 v4, 16, v44
  v_and_b32 v5, 0xffff0000, v44
  v_lshlrev_b32 v10, 16, v46
  v_and_b32 v11, 0xffff0000, v46
  v_add_f32 v6, v6, v4
  v_add_f32 v7, v7, v5
  v_add_f32 v8, v8, v10
  v_add_f32 v9, v9, v11
  v_lshlrev_b32 v4, 16, v48
  v_and_b32 v5, 0xffff0000, v48
  v_lshlrev_b32 v10, 16, v50
  v_and_b32 v11, 0xffff0000, v50
  v_add_f32 v6, v6, v4
  v_add_f32 v7, v7, v5
  v_add_f32 v8, v8, v10
  v_add_f32 v9, v9, v11
  v_lshlrev_b32 v4, 16, v100
  v_and_b32 v5, 0xffff0000, v100
  v_permlane32_swap_b32 v6, v8
  v_permlane32_swap_b32 v7, v9
  s_waitcnt lgkmcnt(0)
  v_readfirstlane_b32 s59, v12
  v_add_f32 v6, v6, v8
  v_add_f32 v7, v7, v9
  v_cvt_pk_bf16_f32 v6, v6, v7
  v_and_b32 v7, 0xffff0000, v6
  v_lshlrev_b32 v6, 16, v6
  v_add_f32 v6, v6, v4
  v_add_f32 v7, v7, v5
  v_cvt_pk_bf16_f32 v6, v6, v7
  v_and_b32 v7, 0xffff0000, v6
  v_lshlrev_b32 v6, 16, v6
  v_mul_f32 v8, 0xBFB8AA3B, v6
  v_mul_f32 v9, 0xBFB8AA3B, v7
  v_exp_f32 v8, v8
  v_exp_f32 v9, v9
  v_mov_b32 v11, s18
  v_add_f32 v8, 1.0, v8
  v_add_f32 v9, 1.0, v9
  v_rcp_f32 v8, v8
  v_rcp_f32 v9, v9
  s_cmp_eq_u32 s59, 0
  v_mul_f32 v6, v6, v8
  v_mul_f32 v7, v7, v9
  v_cvt_pk_bf16_f32 v10, v6, v7
  buffer_store_dwordx2 v[10:11], v102, s[32:35], s46 offen
  s_cbranch_scc1 L_x12_nog
  buffer_store_dwordx2 v[10:11], v102, s[32:35], s47 offen sc1
L_x12_nog:
L_x12_end:
L_exit:
  s_endpgm
L_codeend:
.p2align 12
.fill 256, 4, 0xBF800000
.section .rodata,"a"
.p2align 6
.amdhsa_kernel recurrent_scan__sliding_block_cached__dense_activation_squared_relu__decode_kernel
  .amdhsa_next_free_vgpr 128
  .amdhsa_next_free_sgpr 102
  .amdhsa_accum_offset 128
  .amdhsa_group_segment_fixed_size 0
  .amdhsa_kernarg_size 104
  .amdhsa_user_sgpr_count 2
  .amdhsa_user_sgpr_kernarg_segment_ptr 1
  .amdhsa_system_sgpr_workgroup_id_x 1
  .amdhsa_float_denorm_mode_32 3
.end_amdhsa_kernel
```
